```python
import torch

def _softmax(x, axis=-1):
    return torch.softmax(x, dim=axis)
def _gelu(x):
    return torch.nn.functional.gelu(x, approximate="tanh")
def _silu(x):
    return torch.nn.functional.silu(x)
def _sigmoid(x):
    return torch.sigmoid(x)
def _layernorm(x, axis=-1, eps=1e-5):
    m = x.mean(dim=axis, keepdim=True)
    v = x.var(dim=axis, keepdim=True, unbiased=False)
    return (x - m) / torch.sqrt(v + eps)
def _scatter_add(tgt, idx, src, axis=0):
    return tgt.clone().index_add_(axis, idx, src)
def _segment_sum(src, seg, n):
    out = torch.zeros((n,) + src.shape[1:], dtype=src.dtype)
    return out.index_add_(0, seg, src)
def _pad(x, pw):
    flat = tuple(v for pair in reversed(pw) for v in pair)
    return torch.nn.functional.pad(x, flat)

kernel_name = 'standalone__gqa_block_cached__decode'

def setup_inputs():

    _w = (lambda a: (lambda t: t.to(torch.bfloat16) if t.is_floating_point() else t)(torch.as_tensor(a)))
    B, Sq, D = 1, 1, 640
    Hq, Hkv, Sk, Dh = 32, 32, 8192, 192
    assert Hq % Hkv == 0, (Hq, Hkv)
    return {
        "x": _w((lambda *s: torch.randn(*s, dtype=torch.bfloat16) * 0.8)(B, Sq, D)),
        "k_cache": _w((lambda *s: torch.randn(*s, dtype=torch.bfloat16) * 0.8)(B, Hkv, Sk, Dh)),
        "v_cache": _w((lambda *s: torch.randn(*s, dtype=torch.bfloat16) * 0.05)(B, Hkv, Sk, Dh)),
        "wq": _w((lambda *s: torch.randn(*s, dtype=torch.bfloat16) * 0.8)(D, Hq * Dh) * (D ** -0.5)),
        "wo": _w((lambda *s: torch.randn(*s, dtype=torch.bfloat16) * 0.05)(Hq * Dh, D) * ((Hq * Dh) ** -0.5)),
    }

def reference(x, k_cache, v_cache, wq, wo):
    B, Sq, D = x.shape
    Hq, Dh = 32, 192
    Hkv = k_cache.shape[1]
    rep = Hq // Hkv
    q = (lambda x, *d: x.permute(*d))((x @ wq).reshape(B, Sq, Hq, Dh), 0, 2, 1, 3)
    k = (lambda x, n, axis: torch.repeat_interleave(x, n, dim=axis))(k_cache, rep, axis=1)
    v = (lambda x, n, axis: torch.repeat_interleave(x, n, dim=axis))(v_cache, rep, axis=1)
    scores = torch.einsum("bhqd,bhkd->bhqk", q, k) * (Dh ** -0.5)
    p = _softmax(scores, axis=-1)
    o = torch.einsum("bhqk,bhkd->bhqd", p, v)
    return (lambda x, *d: x.permute(*d))(o, 0, 2, 1, 3).reshape(B, Sq, Hq * Dh) @ wo
```

```asm
; @launch grid=(256,1,1) block=(512,1,1) lds=39936
.amdgcn_target "amdgcn-amd-amdhsa--gfx950"
.text
.globl standalone__gqa_block_cached__decode_kernel
.p2align 8
.type standalone__gqa_block_cached__decode_kernel,@function
standalone__gqa_block_cached__decode_kernel:
s_cmp_ge_u32 s2, 256
s_cbranch_scc1 L_done
s_load_dwordx2 s[32:33], s[0:1], 24
s_load_dwordx2 s[36:37], s[0:1], 0
s_load_dwordx4 s[4:7], s[0:1], 8
s_load_dwordx8 s[12:19], s[0:1], 32
v_lshrrev_b32 v2, 6, v0
v_and_b32 v0, 63, v0
s_and_b32 s44, s2, 7
s_lshl_b32 s44, s44, 2
s_bfe_u32 s47, s2, 0x20003
s_or_b32 s44, s44, s47
s_lshr_b32 s45, s2, 5
v_readfirstlane_b32 s3, v2
v_lshrrev_b32 v2, 3, v0
v_and_b32 v3, 7, v0
v_lshlrev_b32 v3, 4, v3
v_mul_u32_u24 v1, 384, v2
v_add_u32 v1, v1, v3
s_lshl_b32 s55, s44, 3
s_or_b32 s55, s55, s45
s_mul_i32 s46, s44, 3145728
s_lshl_b32 s47, s45, 3
s_add_u32 s47, s47, s3
s_mul_i32 s47, s47, 3072
s_add_u32 s46, s46, s47
s_mov_b32 s22, 100663296
s_mov_b32 s23, 0x20000
s_mov_b32 s34, 7864320
s_mov_b32 s35, 0x20000
s_mov_b32 s38, 1280
s_mov_b32 s39, 0x20000
v_lshrrev_b32 v2, 3, v0
v_lshlrev_b32 v4, 1, v2
v_mul_u32_u24 v5, 12288, v2
v_and_b32 v3, 7, v0
v_lshl_add_u32 v5, v3, 4, v5
s_mul_i32 s47, s45, 10
s_add_u32 s47, s47, s3
s_sub_u32 s47, s47, 1
s_lshl_b32 s48, s47, 4
s_mul_i32 s49, s47, 98304
s_mul_i32 s50, s44, 384
s_add_u32 s49, s49, s50
s_cmp_eq_u32 s3, 0
s_waitcnt lgkmcnt(0)
s_mov_b32 s20, s4
s_mov_b32 s21, s5
s_cbranch_scc1 L_w0
buffer_load_ushort v13, v4, s[36:39], s48 offen
buffer_load_dwordx4 v[222:225], v5, s[32:35], s49 offen offset:0 nt
buffer_load_dwordx4 v[226:229], v5, s[32:35], s49 offen offset:128 nt
buffer_load_dwordx4 v[230:233], v5, s[32:35], s49 offen offset:256 nt
s_cmp_le_u32 s3, 3
s_cbranch_scc0 L_noq2a
s_add_u32 s48, s48, 112
s_add_u32 s49, s49, 688128
buffer_load_ushort v14, v4, s[36:39], s48 offen
buffer_load_dwordx4 v[234:237], v5, s[32:35], s49 offen offset:0 nt
buffer_load_dwordx4 v[238:241], v5, s[32:35], s49 offen offset:128 nt
buffer_load_dwordx4 v[242:245], v5, s[32:35], s49 offen offset:256 nt
L_noq2a:
s_mov_b32 s53, s46
s_waitcnt vmcnt(2)
buffer_load_dwordx4 v[54:57], v1, s[20:23], s53 offen offset:0 nt
s_waitcnt vmcnt(2)
buffer_load_dwordx4 v[58:61], v1, s[20:23], s53 offen offset:128 nt
s_waitcnt vmcnt(2)
buffer_load_dwordx4 v[62:65], v1, s[20:23], s53 offen offset:256 nt
s_load_dword s56, s[18:19], 0
s_mov_b32 s24, s6
s_mov_b32 s25, s7
s_mov_b32 s26, 100663296
s_mov_b32 s27, 0x20000
s_mov_b32 s28, s18
s_mov_b32 s29, s19
s_mov_b32 s30, 1024000
s_mov_b32 s31, 0x20000
s_mov_b32 s52, 0x3dd53b95
s_mov_b32 s58, 0xff00ff00
s_mov_b32 s59, 0xff00ff00
v_mov_b32 v30, 0
v_mov_b32 v31, 0
v_mov_b32 v32, 0
v_mov_b32 v33, 0
v_mov_b32 v34, 0
v_mov_b32 v35, 0
v_mov_b32 v36, 0
v_mov_b32 v37, 0
v_mov_b32 v38, 0
v_mov_b32 v39, 0
v_mov_b32 v40, 0
v_mov_b32 v41, 0
v_mov_b32 v42, 0
v_mov_b32 v43, 0
v_mov_b32 v44, 0
v_mov_b32 v45, 0
v_mov_b32 v46, 0
v_mov_b32 v47, 0
v_mov_b32 v48, 0
v_mov_b32 v49, 0
v_mov_b32 v50, 0
v_mov_b32 v51, 0
v_mov_b32 v52, 0
v_mov_b32 v53, 0
s_waitcnt vmcnt(3)
v_lshlrev_b32 v2, 16, v13
v_dot2c_f32_bf16 v30, v222, v13
v_dot2c_f32_bf16 v31, v222, v2
v_dot2c_f32_bf16 v32, v223, v13
v_dot2c_f32_bf16 v33, v223, v2
v_dot2c_f32_bf16 v34, v224, v13
v_dot2c_f32_bf16 v35, v224, v2
v_dot2c_f32_bf16 v36, v225, v13
v_dot2c_f32_bf16 v37, v225, v2
v_dot2c_f32_bf16 v38, v226, v13
v_dot2c_f32_bf16 v39, v226, v2
v_dot2c_f32_bf16 v40, v227, v13
v_dot2c_f32_bf16 v41, v227, v2
v_dot2c_f32_bf16 v42, v228, v13
v_dot2c_f32_bf16 v43, v228, v2
v_dot2c_f32_bf16 v44, v229, v13
v_dot2c_f32_bf16 v45, v229, v2
v_dot2c_f32_bf16 v46, v230, v13
v_dot2c_f32_bf16 v47, v230, v2
v_dot2c_f32_bf16 v48, v231, v13
v_dot2c_f32_bf16 v49, v231, v2
v_dot2c_f32_bf16 v50, v232, v13
v_dot2c_f32_bf16 v51, v232, v2
v_dot2c_f32_bf16 v52, v233, v13
v_dot2c_f32_bf16 v53, v233, v2
s_cmp_le_u32 s3, 3
s_cbranch_scc0 L_noq2b
v_lshlrev_b32 v2, 16, v14
v_dot2c_f32_bf16 v30, v234, v14
v_dot2c_f32_bf16 v31, v234, v2
v_dot2c_f32_bf16 v32, v235, v14
v_dot2c_f32_bf16 v33, v235, v2
v_dot2c_f32_bf16 v34, v236, v14
v_dot2c_f32_bf16 v35, v236, v2
v_dot2c_f32_bf16 v36, v237, v14
v_dot2c_f32_bf16 v37, v237, v2
v_dot2c_f32_bf16 v38, v238, v14
v_dot2c_f32_bf16 v39, v238, v2
v_dot2c_f32_bf16 v40, v239, v14
v_dot2c_f32_bf16 v41, v239, v2
v_dot2c_f32_bf16 v42, v240, v14
v_dot2c_f32_bf16 v43, v240, v2
v_dot2c_f32_bf16 v44, v241, v14
v_dot2c_f32_bf16 v45, v241, v2
v_dot2c_f32_bf16 v46, v242, v14
v_dot2c_f32_bf16 v47, v242, v2
v_dot2c_f32_bf16 v48, v243, v14
v_dot2c_f32_bf16 v49, v243, v2
v_dot2c_f32_bf16 v50, v244, v14
v_dot2c_f32_bf16 v51, v244, v2
v_dot2c_f32_bf16 v52, v245, v14
v_dot2c_f32_bf16 v53, v245, v2
L_noq2b:
s_nop 2
v_permlane32_swap_b32 v30, v34
v_permlane32_swap_b32 v31, v35
v_permlane32_swap_b32 v32, v36
v_permlane32_swap_b32 v33, v37
v_permlane32_swap_b32 v38, v42
v_permlane32_swap_b32 v39, v43
v_permlane32_swap_b32 v40, v44
v_permlane32_swap_b32 v41, v45
v_permlane32_swap_b32 v46, v50
v_permlane32_swap_b32 v47, v51
v_permlane32_swap_b32 v48, v52
v_permlane32_swap_b32 v49, v53
v_add_f32 v30, v30, v34
v_add_f32 v31, v31, v35
v_add_f32 v32, v32, v36
v_add_f32 v33, v33, v37
v_add_f32 v38, v38, v42
v_add_f32 v39, v39, v43
v_add_f32 v40, v40, v44
v_add_f32 v41, v41, v45
v_add_f32 v46, v46, v50
v_add_f32 v47, v47, v51
v_add_f32 v48, v48, v52
v_add_f32 v49, v49, v53
s_nop 1
v_permlane16_swap_b32 v30, v32
v_permlane16_swap_b32 v31, v33
v_permlane16_swap_b32 v38, v40
v_permlane16_swap_b32 v39, v41
v_permlane16_swap_b32 v46, v48
v_permlane16_swap_b32 v47, v49
v_add_f32 v30, v30, v32
v_add_f32 v31, v31, v33
v_add_f32 v38, v38, v40
v_add_f32 v39, v39, v41
v_add_f32 v46, v46, v48
v_add_f32 v47, v47, v49
s_nop 1
v_add_f32_dpp v30, v30, v30 row_ror:8 row_mask:0xf bank_mask:0xf
v_add_f32_dpp v31, v31, v31 row_ror:8 row_mask:0xf bank_mask:0xf
v_add_f32_dpp v38, v38, v38 row_ror:8 row_mask:0xf bank_mask:0xf
v_add_f32_dpp v39, v39, v39 row_ror:8 row_mask:0xf bank_mask:0xf
v_add_f32_dpp v46, v46, v46 row_ror:8 row_mask:0xf bank_mask:0xf
v_add_f32_dpp v47, v47, v47 row_ror:8 row_mask:0xf bank_mask:0xf
v_cndmask_b32 v6, v30, v39, s[58:59]
v_cndmask_b32 v7, v31, v46, s[58:59]
v_cndmask_b32 v8, v38, v47, s[58:59]
v_lshlrev_b32 v3, 4, v0
s_lshl_b32 s47, s3, 10
v_add_u32 v2, s47, v3
ds_write_b128 v2, v[6:9] offset:1024
s_add_u32 s53, s53, 196608
s_waitcnt vmcnt(2)
buffer_load_dwordx4 v[66:69], v1, s[20:23], s53 offen offset:0 nt
s_waitcnt vmcnt(2)
buffer_load_dwordx4 v[70:73], v1, s[20:23], s53 offen offset:128 nt
s_waitcnt vmcnt(2)
buffer_load_dwordx4 v[74:77], v1, s[20:23], s53 offen offset:256 nt
s_waitcnt lgkmcnt(0)
s_add_u32 s56, s56, 0x9e3779b9
s_barrier
s_add_u32 s53, s53, 196608
s_waitcnt vmcnt(2)
buffer_load_dwordx4 v[78:81], v1, s[20:23], s53 offen offset:0 nt
s_waitcnt vmcnt(2)
buffer_load_dwordx4 v[82:85], v1, s[20:23], s53 offen offset:128 nt
s_waitcnt vmcnt(2)
buffer_load_dwordx4 v[86:89], v1, s[20:23], s53 offen offset:256 nt
s_add_u32 s53, s53, 196608
s_waitcnt vmcnt(2)
buffer_load_dwordx4 v[90:93], v1, s[20:23], s53 offen offset:0 nt
s_waitcnt vmcnt(2)
buffer_load_dwordx4 v[94:97], v1, s[20:23], s53 offen offset:128 nt
s_waitcnt vmcnt(2)
buffer_load_dwordx4 v[98:101], v1, s[20:23], s53 offen offset:256 nt
s_add_u32 s53, s53, 196608
s_waitcnt vmcnt(2)
buffer_load_dwordx4 v[102:105], v1, s[20:23], s53 offen offset:0 nt
s_waitcnt vmcnt(2)
buffer_load_dwordx4 v[106:109], v1, s[20:23], s53 offen offset:128 nt
s_waitcnt vmcnt(2)
buffer_load_dwordx4 v[110:113], v1, s[20:23], s53 offen offset:256 nt
s_add_u32 s53, s53, 196608
s_waitcnt vmcnt(2)
buffer_load_dwordx4 v[114:117], v1, s[20:23], s53 offen offset:0 nt
s_waitcnt vmcnt(2)
buffer_load_dwordx4 v[118:121], v1, s[20:23], s53 offen offset:128 nt
s_waitcnt vmcnt(2)
buffer_load_dwordx4 v[122:125], v1, s[20:23], s53 offen offset:256 nt
s_add_u32 s53, s53, 196608
s_waitcnt vmcnt(2)
buffer_load_dwordx4 v[126:129], v1, s[20:23], s53 offen offset:0 nt
s_waitcnt vmcnt(2)
buffer_load_dwordx4 v[130:133], v1, s[20:23], s53 offen offset:128 nt
s_waitcnt vmcnt(2)
buffer_load_dwordx4 v[134:137], v1, s[20:23], s53 offen offset:256 nt
s_add_u32 s53, s53, 196608
s_waitcnt vmcnt(2)
buffer_load_dwordx4 v[138:141], v1, s[20:23], s53 offen offset:0 nt
s_waitcnt vmcnt(2)
buffer_load_dwordx4 v[142:145], v1, s[20:23], s53 offen offset:128 nt
s_waitcnt vmcnt(2)
buffer_load_dwordx4 v[146:149], v1, s[20:23], s53 offen offset:256 nt
s_add_u32 s53, s53, 196608
s_waitcnt vmcnt(2)
buffer_load_dwordx4 v[150:153], v1, s[20:23], s53 offen offset:0 nt
s_waitcnt vmcnt(2)
buffer_load_dwordx4 v[154:157], v1, s[20:23], s53 offen offset:128 nt
s_waitcnt vmcnt(2)
buffer_load_dwordx4 v[158:161], v1, s[20:23], s53 offen offset:256 nt
s_add_u32 s53, s53, 196608
s_waitcnt vmcnt(2)
buffer_load_dwordx4 v[162:165], v1, s[20:23], s53 offen offset:0 nt
s_waitcnt vmcnt(2)
buffer_load_dwordx4 v[166:169], v1, s[20:23], s53 offen offset:128 nt
s_waitcnt vmcnt(2)
buffer_load_dwordx4 v[170:173], v1, s[20:23], s53 offen offset:256 nt
s_add_u32 s53, s53, 196608
s_waitcnt vmcnt(2)
buffer_load_dwordx4 v[174:177], v1, s[20:23], s53 offen offset:0 nt
s_waitcnt vmcnt(2)
buffer_load_dwordx4 v[178:181], v1, s[20:23], s53 offen offset:128 nt
s_waitcnt vmcnt(2)
buffer_load_dwordx4 v[182:185], v1, s[20:23], s53 offen offset:256 nt
v_mov_b32 v2, 0
s_mov_b32 s51, 200000
L_qw:
ds_read_b32 v3, v2 offset:832
s_waitcnt lgkmcnt(0)
v_cmp_eq_u32 vcc, 0, v3
s_cbranch_vccz L_qwok
s_sub_u32 s51, s51, 1
s_cmp_lg_u32 s51, 0
s_cbranch_scc1 L_qw
L_qwok:
v_and_b32 v2, 7, v0
v_lshlrev_b32 v2, 4, v2
ds_read_b128 v[30:33], v2 offset:0
ds_read_b128 v[34:37], v2 offset:128
ds_read_b128 v[38:41], v2 offset:256
s_waitcnt lgkmcnt(0)
s_add_u32 s53, s53, 196608
s_waitcnt vmcnt(2)
buffer_load_dwordx4 v[186:189], v1, s[20:23], s53 offen offset:0 nt
s_waitcnt vmcnt(31)
v_dot2_f32_bf16 v6, v54, v30, 0
v_dot2_f32_bf16 v7, v55, v31, 0
v_dot2_f32_bf16 v6, v56, v32, v6
v_dot2_f32_bf16 v7, v57, v33, v7
v_dot2_f32_bf16 v6, v58, v34, v6
v_dot2_f32_bf16 v7, v59, v35, v7
v_dot2_f32_bf16 v6, v60, v36, v6
v_dot2_f32_bf16 v7, v61, v37, v7
v_dot2_f32_bf16 v6, v62, v38, v6
v_dot2_f32_bf16 v7, v63, v39, v7
v_dot2_f32_bf16 v6, v64, v40, v6
v_dot2_f32_bf16 v7, v65, v41, v7
s_waitcnt vmcnt(2)
buffer_load_dwordx4 v[190:193], v1, s[20:23], s53 offen offset:128 nt
s_waitcnt vmcnt(29)
v_dot2_f32_bf16 v8, v66, v30, 0
v_dot2_f32_bf16 v9, v67, v31, 0
v_dot2_f32_bf16 v8, v68, v32, v8
v_add_f32 v6, v6, v7
v_dot2_f32_bf16 v9, v69, v33, v9
v_dot2_f32_bf16 v8, v70, v34, v8
v_dot2_f32_bf16 v9, v71, v35, v9
v_add_f32_dpp v6, v6, v6 quad_perm:[1,0,3,2] row_mask:0xf bank_mask:0xf
v_dot2_f32_bf16 v8, v72, v36, v8
v_dot2_f32_bf16 v9, v73, v37, v9
v_dot2_f32_bf16 v8, v74, v38, v8
v_add_f32_dpp v6, v6, v6 quad_perm:[2,3,0,1] row_mask:0xf bank_mask:0xf
v_dot2_f32_bf16 v9, v75, v39, v9
v_dot2_f32_bf16 v8, v76, v40, v8
v_dot2_f32_bf16 v9, v77, v41, v9
v_add_f32_dpp v13, v6, v6 row_half_mirror row_mask:0xf bank_mask:0xf
s_waitcnt vmcnt(2)
buffer_load_dwordx4 v[194:197], v1, s[20:23], s53 offen offset:256 nt
s_waitcnt vmcnt(27)
v_dot2_f32_bf16 v6, v78, v30, 0
v_dot2_f32_bf16 v7, v79, v31, 0
v_dot2_f32_bf16 v6, v80, v32, v6
v_add_f32 v8, v8, v9
v_dot2_f32_bf16 v7, v81, v33, v7
v_dot2_f32_bf16 v6, v82, v34, v6
v_dot2_f32_bf16 v7, v83, v35, v7
v_add_f32_dpp v8, v8, v8 quad_perm:[1,0,3,2] row_mask:0xf bank_mask:0xf
v_dot2_f32_bf16 v6, v84, v36, v6
v_dot2_f32_bf16 v7, v85, v37, v7
v_dot2_f32_bf16 v6, v86, v38, v6
v_add_f32_dpp v8, v8, v8 quad_perm:[2,3,0,1] row_mask:0xf bank_mask:0xf
v_dot2_f32_bf16 v7, v87, v39, v7
v_dot2_f32_bf16 v6, v88, v40, v6
v_dot2_f32_bf16 v7, v89, v41, v7
v_add_f32_dpp v14, v8, v8 row_half_mirror row_mask:0xf bank_mask:0xf
s_mov_b32 s32, s12
s_mov_b32 s33, s13
s_mov_b32 s34, 7864320
s_mov_b32 s35, 0x20000
s_mul_i32 s100, s44, 245760
s_mul_i32 s101, s45, 30720
s_add_u32 s100, s100, s101
s_lshl_b32 s101, s3, 10
s_add_u32 s101, s101, 0
v_lshlrev_b32 v3, 4, v0
v_add_u32 v3, s101, v3
s_waitcnt vmcnt(2)
buffer_load_dwordx4 v[42:45], v3, s[32:35], s100 offen
s_waitcnt vmcnt(25)
v_dot2_f32_bf16 v8, v90, v30, 0
v_dot2_f32_bf16 v9, v91, v31, 0
v_dot2_f32_bf16 v8, v92, v32, v8
v_add_f32 v6, v6, v7
v_dot2_f32_bf16 v9, v93, v33, v9
v_dot2_f32_bf16 v8, v94, v34, v8
v_dot2_f32_bf16 v9, v95, v35, v9
v_add_f32_dpp v6, v6, v6 quad_perm:[1,0,3,2] row_mask:0xf bank_mask:0xf
v_dot2_f32_bf16 v8, v96, v36, v8
v_dot2_f32_bf16 v9, v97, v37, v9
v_dot2_f32_bf16 v8, v98, v38, v8
v_add_f32_dpp v6, v6, v6 quad_perm:[2,3,0,1] row_mask:0xf bank_mask:0xf
v_dot2_f32_bf16 v9, v99, v39, v9
v_dot2_f32_bf16 v8, v100, v40, v8
v_dot2_f32_bf16 v9, v101, v41, v9
v_add_f32_dpp v15, v6, v6 row_half_mirror row_mask:0xf bank_mask:0xf
s_add_u32 s53, s53, 196608
s_waitcnt vmcnt(2)
buffer_load_dwordx4 v[198:201], v1, s[20:23], s53 offen offset:0 nt
s_waitcnt vmcnt(23)
v_dot2_f32_bf16 v6, v102, v30, 0
v_dot2_f32_bf16 v7, v103, v31, 0
v_dot2_f32_bf16 v6, v104, v32, v6
v_add_f32 v8, v8, v9
v_dot2_f32_bf16 v7, v105, v33, v7
v_dot2_f32_bf16 v6, v106, v34, v6
v_dot2_f32_bf16 v7, v107, v35, v7
v_add_f32_dpp v8, v8, v8 quad_perm:[1,0,3,2] row_mask:0xf bank_mask:0xf
v_dot2_f32_bf16 v6, v108, v36, v6
v_dot2_f32_bf16 v7, v109, v37, v7
v_dot2_f32_bf16 v6, v110, v38, v6
v_add_f32_dpp v8, v8, v8 quad_perm:[2,3,0,1] row_mask:0xf bank_mask:0xf
v_dot2_f32_bf16 v7, v111, v39, v7
v_dot2_f32_bf16 v6, v112, v40, v6
v_dot2_f32_bf16 v7, v113, v41, v7
v_add_f32_dpp v16, v8, v8 row_half_mirror row_mask:0xf bank_mask:0xf
s_waitcnt vmcnt(2)
buffer_load_dwordx4 v[202:205], v1, s[20:23], s53 offen offset:128 nt
s_waitcnt vmcnt(21)
v_dot2_f32_bf16 v8, v114, v30, 0
v_dot2_f32_bf16 v9, v115, v31, 0
v_dot2_f32_bf16 v8, v116, v32, v8
v_add_f32 v6, v6, v7
v_dot2_f32_bf16 v9, v117, v33, v9
v_dot2_f32_bf16 v8, v118, v34, v8
v_dot2_f32_bf16 v9, v119, v35, v9
v_add_f32_dpp v6, v6, v6 quad_perm:[1,0,3,2] row_mask:0xf bank_mask:0xf
v_dot2_f32_bf16 v8, v120, v36, v8
v_dot2_f32_bf16 v9, v121, v37, v9
v_dot2_f32_bf16 v8, v122, v38, v8
v_add_f32_dpp v6, v6, v6 quad_perm:[2,3,0,1] row_mask:0xf bank_mask:0xf
v_dot2_f32_bf16 v9, v123, v39, v9
v_dot2_f32_bf16 v8, v124, v40, v8
v_dot2_f32_bf16 v9, v125, v41, v9
v_add_f32_dpp v17, v6, v6 row_half_mirror row_mask:0xf bank_mask:0xf
s_waitcnt vmcnt(2)
buffer_load_dwordx4 v[206:209], v1, s[20:23], s53 offen offset:256 nt
s_waitcnt vmcnt(19)
v_dot2_f32_bf16 v6, v126, v30, 0
v_dot2_f32_bf16 v7, v127, v31, 0
v_dot2_f32_bf16 v6, v128, v32, v6
v_add_f32 v8, v8, v9
v_dot2_f32_bf16 v7, v129, v33, v7
v_dot2_f32_bf16 v6, v130, v34, v6
v_dot2_f32_bf16 v7, v131, v35, v7
v_add_f32_dpp v8, v8, v8 quad_perm:[1,0,3,2] row_mask:0xf bank_mask:0xf
v_dot2_f32_bf16 v6, v132, v36, v6
v_dot2_f32_bf16 v7, v133, v37, v7
v_dot2_f32_bf16 v6, v134, v38, v6
v_add_f32_dpp v8, v8, v8 quad_perm:[2,3,0,1] row_mask:0xf bank_mask:0xf
v_dot2_f32_bf16 v7, v135, v39, v7
v_dot2_f32_bf16 v6, v136, v40, v6
v_dot2_f32_bf16 v7, v137, v41, v7
v_add_f32_dpp v18, v8, v8 row_half_mirror row_mask:0xf bank_mask:0xf
s_lshl_b32 s101, s3, 10
s_add_u32 s101, s101, 8192
v_lshlrev_b32 v3, 4, v0
v_add_u32 v3, s101, v3
s_waitcnt vmcnt(2)
buffer_load_dwordx4 v[42:45], v3, s[32:35], s100 offen
s_waitcnt vmcnt(17)
v_dot2_f32_bf16 v8, v138, v30, 0
v_dot2_f32_bf16 v9, v139, v31, 0
v_dot2_f32_bf16 v8, v140, v32, v8
v_add_f32 v6, v6, v7
v_dot2_f32_bf16 v9, v141, v33, v9
v_dot2_f32_bf16 v8, v142, v34, v8
v_dot2_f32_bf16 v9, v143, v35, v9
v_add_f32_dpp v6, v6, v6 quad_perm:[1,0,3,2] row_mask:0xf bank_mask:0xf
v_dot2_f32_bf16 v8, v144, v36, v8
v_dot2_f32_bf16 v9, v145, v37, v9
v_dot2_f32_bf16 v8, v146, v38, v8
v_add_f32_dpp v6, v6, v6 quad_perm:[2,3,0,1] row_mask:0xf bank_mask:0xf
v_dot2_f32_bf16 v9, v147, v39, v9
v_dot2_f32_bf16 v8, v148, v40, v8
v_dot2_f32_bf16 v9, v149, v41, v9
v_add_f32_dpp v19, v6, v6 row_half_mirror row_mask:0xf bank_mask:0xf
s_add_u32 s53, s53, 196608
s_waitcnt vmcnt(2)
buffer_load_dwordx4 v[210:213], v1, s[20:23], s53 offen offset:0 nt
s_waitcnt vmcnt(15)
v_dot2_f32_bf16 v6, v150, v30, 0
v_dot2_f32_bf16 v7, v151, v31, 0
v_dot2_f32_bf16 v6, v152, v32, v6
v_add_f32 v8, v8, v9
v_dot2_f32_bf16 v7, v153, v33, v7
v_dot2_f32_bf16 v6, v154, v34, v6
v_dot2_f32_bf16 v7, v155, v35, v7
v_add_f32_dpp v8, v8, v8 quad_perm:[1,0,3,2] row_mask:0xf bank_mask:0xf
v_dot2_f32_bf16 v6, v156, v36, v6
v_dot2_f32_bf16 v7, v157, v37, v7
v_dot2_f32_bf16 v6, v158, v38, v6
v_add_f32_dpp v8, v8, v8 quad_perm:[2,3,0,1] row_mask:0xf bank_mask:0xf
v_dot2_f32_bf16 v7, v159, v39, v7
v_dot2_f32_bf16 v6, v160, v40, v6
v_dot2_f32_bf16 v7, v161, v41, v7
v_add_f32_dpp v20, v8, v8 row_half_mirror row_mask:0xf bank_mask:0xf
s_waitcnt vmcnt(2)
buffer_load_dwordx4 v[214:217], v1, s[20:23], s53 offen offset:128 nt
s_waitcnt vmcnt(13)
v_dot2_f32_bf16 v8, v162, v30, 0
v_dot2_f32_bf16 v9, v163, v31, 0
v_dot2_f32_bf16 v8, v164, v32, v8
v_add_f32 v6, v6, v7
v_dot2_f32_bf16 v9, v165, v33, v9
v_dot2_f32_bf16 v8, v166, v34, v8
v_dot2_f32_bf16 v9, v167, v35, v9
v_add_f32_dpp v6, v6, v6 quad_perm:[1,0,3,2] row_mask:0xf bank_mask:0xf
v_dot2_f32_bf16 v8, v168, v36, v8
v_dot2_f32_bf16 v9, v169, v37, v9
v_dot2_f32_bf16 v8, v170, v38, v8
v_add_f32_dpp v6, v6, v6 quad_perm:[2,3,0,1] row_mask:0xf bank_mask:0xf
v_dot2_f32_bf16 v9, v171, v39, v9
v_dot2_f32_bf16 v8, v172, v40, v8
v_dot2_f32_bf16 v9, v173, v41, v9
v_add_f32_dpp v21, v6, v6 row_half_mirror row_mask:0xf bank_mask:0xf
s_waitcnt vmcnt(2)
buffer_load_dwordx4 v[218:221], v1, s[20:23], s53 offen offset:256 nt
s_waitcnt vmcnt(11)
v_dot2_f32_bf16 v6, v174, v30, 0
v_dot2_f32_bf16 v7, v175, v31, 0
v_dot2_f32_bf16 v6, v176, v32, v6
v_add_f32 v8, v8, v9
v_dot2_f32_bf16 v7, v177, v33, v7
v_dot2_f32_bf16 v6, v178, v34, v6
v_dot2_f32_bf16 v7, v179, v35, v7
v_add_f32_dpp v8, v8, v8 quad_perm:[1,0,3,2] row_mask:0xf bank_mask:0xf
v_dot2_f32_bf16 v6, v180, v36, v6
v_dot2_f32_bf16 v7, v181, v37, v7
v_dot2_f32_bf16 v6, v182, v38, v6
v_add_f32_dpp v8, v8, v8 quad_perm:[2,3,0,1] row_mask:0xf bank_mask:0xf
v_dot2_f32_bf16 v7, v183, v39, v7
v_dot2_f32_bf16 v6, v184, v40, v6
v_dot2_f32_bf16 v7, v185, v41, v7
v_add_f32_dpp v22, v8, v8 row_half_mirror row_mask:0xf bank_mask:0xf
s_lshl_b32 s101, s3, 10
s_add_u32 s101, s101, 16384
v_lshlrev_b32 v3, 4, v0
v_add_u32 v3, s101, v3
s_waitcnt vmcnt(2)
buffer_load_dwordx4 v[42:45], v3, s[32:35], s100 offen
s_waitcnt vmcnt(9)
v_dot2_f32_bf16 v8, v186, v30, 0
v_dot2_f32_bf16 v9, v187, v31, 0
v_dot2_f32_bf16 v8, v188, v32, v8
v_add_f32 v6, v6, v7
v_dot2_f32_bf16 v9, v189, v33, v9
v_dot2_f32_bf16 v8, v190, v34, v8
v_dot2_f32_bf16 v9, v191, v35, v9
v_add_f32_dpp v6, v6, v6 quad_perm:[1,0,3,2] row_mask:0xf bank_mask:0xf
v_dot2_f32_bf16 v8, v192, v36, v8
v_dot2_f32_bf16 v9, v193, v37, v9
v_dot2_f32_bf16 v8, v194, v38, v8
v_add_f32_dpp v6, v6, v6 quad_perm:[2,3,0,1] row_mask:0xf bank_mask:0xf
v_dot2_f32_bf16 v9, v195, v39, v9
v_dot2_f32_bf16 v8, v196, v40, v8
v_dot2_f32_bf16 v9, v197, v41, v9
v_add_f32_dpp v23, v6, v6 row_half_mirror row_mask:0xf bank_mask:0xf
s_add_u32 s53, s53, 196608
s_waitcnt vmcnt(2)
buffer_load_dwordx4 v[222:225], v1, s[20:23], s53 offen offset:0 nt
s_waitcnt vmcnt(6)
v_dot2_f32_bf16 v6, v198, v30, 0
v_dot2_f32_bf16 v7, v199, v31, 0
v_dot2_f32_bf16 v6, v200, v32, v6
v_add_f32 v8, v8, v9
v_dot2_f32_bf16 v7, v201, v33, v7
v_dot2_f32_bf16 v6, v202, v34, v6
v_dot2_f32_bf16 v7, v203, v35, v7
v_add_f32_dpp v8, v8, v8 quad_perm:[1,0,3,2] row_mask:0xf bank_mask:0xf
v_dot2_f32_bf16 v6, v204, v36, v6
v_dot2_f32_bf16 v7, v205, v37, v7
v_dot2_f32_bf16 v6, v206, v38, v6
v_add_f32_dpp v8, v8, v8 quad_perm:[2,3,0,1] row_mask:0xf bank_mask:0xf
v_dot2_f32_bf16 v7, v207, v39, v7
v_dot2_f32_bf16 v6, v208, v40, v6
v_dot2_f32_bf16 v7, v209, v41, v7
v_add_f32_dpp v24, v8, v8 row_half_mirror row_mask:0xf bank_mask:0xf
s_waitcnt vmcnt(2)
buffer_load_dwordx4 v[226:229], v1, s[20:23], s53 offen offset:128 nt
s_waitcnt vmcnt(3)
v_dot2_f32_bf16 v8, v210, v30, 0
v_dot2_f32_bf16 v9, v211, v31, 0
v_dot2_f32_bf16 v8, v212, v32, v8
v_add_f32 v6, v6, v7
v_dot2_f32_bf16 v9, v213, v33, v9
v_dot2_f32_bf16 v8, v214, v34, v8
v_dot2_f32_bf16 v9, v215, v35, v9
v_add_f32_dpp v6, v6, v6 quad_perm:[1,0,3,2] row_mask:0xf bank_mask:0xf
v_dot2_f32_bf16 v8, v216, v36, v8
v_dot2_f32_bf16 v9, v217, v37, v9
v_dot2_f32_bf16 v8, v218, v38, v8
v_add_f32_dpp v6, v6, v6 quad_perm:[2,3,0,1] row_mask:0xf bank_mask:0xf
v_dot2_f32_bf16 v9, v219, v39, v9
v_dot2_f32_bf16 v8, v220, v40, v8
v_dot2_f32_bf16 v9, v221, v41, v9
v_add_f32_dpp v25, v6, v6 row_half_mirror row_mask:0xf bank_mask:0xf
s_waitcnt vmcnt(2)
buffer_load_dwordx4 v[230:233], v1, s[20:23], s53 offen offset:256 nt
s_cmp_ge_u32 s3, 6
s_cbranch_scc1 L_pf0
s_lshl_b32 s101, s3, 10
s_add_u32 s101, s101, 24576
v_lshlrev_b32 v3, 4, v0
v_add_u32 v3, s101, v3
s_waitcnt vmcnt(2)
buffer_load_dwordx4 v[42:45], v3, s[32:35], s100 offen
L_pf0:
s_add_u32 s53, s53, 196608
s_waitcnt vmcnt(2)
buffer_load_dwordx4 v[234:237], v1, s[20:23], s53 offen offset:0 nt
s_waitcnt vmcnt(2)
buffer_load_dwordx4 v[238:241], v1, s[20:23], s53 offen offset:128 nt
s_waitcnt vmcnt(2)
buffer_load_dwordx4 v[242:245], v1, s[20:23], s53 offen offset:256 nt
s_waitcnt vmcnt(3)
v_dot2_f32_bf16 v6, v222, v30, 0
v_dot2_f32_bf16 v7, v223, v31, 0
v_dot2_f32_bf16 v6, v224, v32, v6
v_add_f32 v8, v8, v9
v_dot2_f32_bf16 v7, v225, v33, v7
v_dot2_f32_bf16 v6, v226, v34, v6
v_dot2_f32_bf16 v7, v227, v35, v7
v_add_f32_dpp v8, v8, v8 quad_perm:[1,0,3,2] row_mask:0xf bank_mask:0xf
v_dot2_f32_bf16 v6, v228, v36, v6
v_dot2_f32_bf16 v7, v229, v37, v7
v_dot2_f32_bf16 v6, v230, v38, v6
v_add_f32_dpp v8, v8, v8 quad_perm:[2,3,0,1] row_mask:0xf bank_mask:0xf
v_dot2_f32_bf16 v7, v231, v39, v7
v_dot2_f32_bf16 v6, v232, v40, v6
v_dot2_f32_bf16 v7, v233, v41, v7
v_add_f32_dpp v26, v8, v8 row_half_mirror row_mask:0xf bank_mask:0xf
s_mov_b32 s54, s46
s_waitcnt vmcnt(2)
buffer_load_dwordx4 v[54:57], v1, s[24:27], s54 offen offset:0 nt
s_waitcnt vmcnt(2)
buffer_load_dwordx4 v[58:61], v1, s[24:27], s54 offen offset:128 nt
s_waitcnt vmcnt(2)
buffer_load_dwordx4 v[62:65], v1, s[24:27], s54 offen offset:256 nt
s_waitcnt vmcnt(3)
v_dot2_f32_bf16 v8, v234, v30, 0
v_dot2_f32_bf16 v9, v235, v31, 0
v_dot2_f32_bf16 v8, v236, v32, v8
v_add_f32 v6, v6, v7
v_dot2_f32_bf16 v9, v237, v33, v9
v_dot2_f32_bf16 v8, v238, v34, v8
v_dot2_f32_bf16 v9, v239, v35, v9
v_add_f32_dpp v6, v6, v6 quad_perm:[1,0,3,2] row_mask:0xf bank_mask:0xf
v_dot2_f32_bf16 v8, v240, v36, v8
v_dot2_f32_bf16 v9, v241, v37, v9
v_dot2_f32_bf16 v8, v242, v38, v8
v_add_f32_dpp v6, v6, v6 quad_perm:[2,3,0,1] row_mask:0xf bank_mask:0xf
v_dot2_f32_bf16 v9, v243, v39, v9
v_dot2_f32_bf16 v8, v244, v40, v8
v_dot2_f32_bf16 v9, v245, v41, v9
v_add_f32_dpp v27, v6, v6 row_half_mirror row_mask:0xf bank_mask:0xf
s_add_u32 s54, s54, 196608
s_waitcnt vmcnt(2)
buffer_load_dwordx4 v[66:69], v1, s[24:27], s54 offen offset:0 nt
s_nop 2
v_add_f32 v8, v8, v9
s_nop 1
v_add_f32_dpp v8, v8, v8 quad_perm:[1,0,3,2] row_mask:0xf bank_mask:0xf
s_nop 1
v_add_f32_dpp v8, v8, v8 quad_perm:[2,3,0,1] row_mask:0xf bank_mask:0xf
s_nop 1
v_add_f32_dpp v28, v8, v8 row_half_mirror row_mask:0xf bank_mask:0xf
s_nop 1
v_max3_f32 v6, v13, v14, v15
v_max3_f32 v6, v6, v16, v17
v_max3_f32 v6, v6, v18, v19
v_max3_f32 v6, v6, v20, v21
v_max3_f32 v6, v6, v22, v23
v_max3_f32 v6, v6, v24, v25
v_max3_f32 v6, v6, v26, v27
v_max_f32 v6, v6, v28
s_nop 1
v_max_f32_dpp v6, v6, v6 row_ror:8 row_mask:0xf bank_mask:0xf
v_mov_b32 v3, v6
s_nop 1
v_permlane16_swap_b32 v6, v3
v_max_f32 v6, v6, v3
v_mov_b32 v3, v6
s_nop 1
v_permlane32_swap_b32 v6, v3
v_max_f32 v6, v6, v3
v_mul_f32 v8, s52, v6
s_waitcnt vmcnt(2)
buffer_load_dwordx4 v[70:73], v1, s[24:27], s54 offen offset:128 nt
v_fma_f32 v13, v13, s52, -v8
v_fma_f32 v14, v14, s52, -v8
v_fma_f32 v15, v15, s52, -v8
v_fma_f32 v16, v16, s52, -v8
v_fma_f32 v17, v17, s52, -v8
v_fma_f32 v18, v18, s52, -v8
v_fma_f32 v19, v19, s52, -v8
v_fma_f32 v20, v20, s52, -v8
v_fma_f32 v21, v21, s52, -v8
v_fma_f32 v22, v22, s52, -v8
v_fma_f32 v23, v23, s52, -v8
v_fma_f32 v24, v24, s52, -v8
v_fma_f32 v25, v25, s52, -v8
v_fma_f32 v26, v26, s52, -v8
v_fma_f32 v27, v27, s52, -v8
v_fma_f32 v28, v28, s52, -v8
v_exp_f32 v13, v13
v_exp_f32 v14, v14
v_exp_f32 v15, v15
v_exp_f32 v16, v16
v_exp_f32 v17, v17
v_exp_f32 v18, v18
v_exp_f32 v19, v19
v_exp_f32 v20, v20
v_exp_f32 v21, v21
v_exp_f32 v22, v22
v_exp_f32 v23, v23
v_exp_f32 v24, v24
v_exp_f32 v25, v25
v_exp_f32 v26, v26
v_exp_f32 v27, v27
v_exp_f32 v28, v28
s_waitcnt vmcnt(2)
buffer_load_dwordx4 v[74:77], v1, s[24:27], s54 offen offset:256 nt
v_add_f32 v7, v13, v14
v_add_f32 v7, v7, v15
v_add_f32 v7, v7, v16
v_add_f32 v7, v7, v17
v_add_f32 v7, v7, v18
v_add_f32 v7, v7, v19
v_add_f32 v7, v7, v20
v_add_f32 v7, v7, v21
v_add_f32 v7, v7, v22
v_add_f32 v7, v7, v23
v_add_f32 v7, v7, v24
v_add_f32 v7, v7, v25
v_add_f32 v7, v7, v26
v_add_f32 v7, v7, v27
v_add_f32 v7, v7, v28
v_cvt_pk_bf16_f32 v13, v13, 0
v_cvt_pk_bf16_f32 v14, v14, 0
v_cvt_pk_bf16_f32 v15, v15, 0
v_cvt_pk_bf16_f32 v16, v16, 0
v_cvt_pk_bf16_f32 v17, v17, 0
v_cvt_pk_bf16_f32 v18, v18, 0
v_cvt_pk_bf16_f32 v19, v19, 0
v_cvt_pk_bf16_f32 v20, v20, 0
v_cvt_pk_bf16_f32 v21, v21, 0
v_cvt_pk_bf16_f32 v22, v22, 0
v_cvt_pk_bf16_f32 v23, v23, 0
v_cvt_pk_bf16_f32 v24, v24, 0
v_cvt_pk_bf16_f32 v25, v25, 0
v_cvt_pk_bf16_f32 v26, v26, 0
v_cvt_pk_bf16_f32 v27, v27, 0
v_cvt_pk_bf16_f32 v28, v28, 0
s_nop 1
v_add_f32_dpp v7, v7, v7 row_ror:8 row_mask:0xf bank_mask:0xf
v_mov_b32 v3, v7
s_nop 1
v_permlane16_swap_b32 v7, v3
v_add_f32 v7, v7, v3
v_mov_b32 v3, v7
s_nop 1
v_permlane32_swap_b32 v7, v3
v_add_f32 v7, v7, v3
s_lshl_b32 s47, s3, 3
v_mov_b32 v5, s47
ds_write_b64 v5, v[6:7] offset:768
v_mov_b32 v4, 0
v_mov_b32 v3, 1
s_waitcnt lgkmcnt(0)
s_mov_b64 exec, 1
ds_add_u32 v4, v3 offset:836
s_mov_b64 exec, -1
s_add_u32 s54, s54, 196608
s_waitcnt vmcnt(2)
buffer_load_dwordx4 v[78:81], v1, s[24:27], s54 offen offset:0 nt
s_mov_b32 s32, s12
s_mov_b32 s33, s13
s_mov_b32 s34, 7864320
s_mov_b32 s35, 0x20000
s_mul_i32 s100, s44, 245760
s_mul_i32 s101, s45, 160
s_add_u32 s100, s100, s101
s_mov_b32 s57, 429496730
v_mov_b32 v30, 0
v_mov_b32 v31, 0
v_mov_b32 v32, 0
v_mov_b32 v33, 0
v_mov_b32 v34, 0
v_mov_b32 v35, 0
v_mov_b32 v36, 0
v_mov_b32 v37, 0
v_mov_b32 v38, 0
v_mov_b32 v39, 0
v_mov_b32 v40, 0
v_mov_b32 v41, 0
v_mov_b32 v42, 0
v_mov_b32 v43, 0
v_mov_b32 v44, 0
v_mov_b32 v45, 0
v_mov_b32 v46, 0
v_mov_b32 v47, 0
v_mov_b32 v48, 0
v_mov_b32 v49, 0
v_mov_b32 v50, 0
v_mov_b32 v51, 0
v_mov_b32 v52, 0
v_mov_b32 v53, 0
v_lshlrev_b32 v10, 4, v0
s_lshl_b32 s47, s3, 10
v_add_u32 v11, s47, v10
s_waitcnt vmcnt(2)
buffer_load_dwordx4 v[82:85], v1, s[24:27], s54 offen offset:128 nt
s_waitcnt vmcnt(7)
v_lshlrev_b32 v2, 16, v13
v_dot2c_f32_bf16 v30, v54, v13
v_dot2c_f32_bf16 v31, v54, v2
v_dot2c_f32_bf16 v32, v55, v13
v_dot2c_f32_bf16 v33, v55, v2
v_dot2c_f32_bf16 v34, v56, v13
v_dot2c_f32_bf16 v35, v56, v2
v_dot2c_f32_bf16 v36, v57, v13
v_dot2c_f32_bf16 v37, v57, v2
s_waitcnt vmcnt(6)
v_dot2c_f32_bf16 v38, v58, v13
v_dot2c_f32_bf16 v39, v58, v2
v_dot2c_f32_bf16 v40, v59, v13
v_dot2c_f32_bf16 v41, v59, v2
v_dot2c_f32_bf16 v42, v60, v13
v_dot2c_f32_bf16 v43, v60, v2
v_dot2c_f32_bf16 v44, v61, v13
v_dot2c_f32_bf16 v45, v61, v2
s_waitcnt vmcnt(2)
buffer_load_dwordx4 v[86:89], v1, s[24:27], s54 offen offset:256 nt
s_waitcnt vmcnt(6)
v_dot2c_f32_bf16 v46, v62, v13
v_dot2c_f32_bf16 v47, v62, v2
v_dot2c_f32_bf16 v48, v63, v13
v_dot2c_f32_bf16 v49, v63, v2
v_dot2c_f32_bf16 v50, v64, v13
v_dot2c_f32_bf16 v51, v64, v2
v_dot2c_f32_bf16 v52, v65, v13
v_dot2c_f32_bf16 v53, v65, v2
s_waitcnt vmcnt(5)
v_lshlrev_b32 v2, 16, v14
v_dot2c_f32_bf16 v30, v66, v14
v_dot2c_f32_bf16 v31, v66, v2
v_dot2c_f32_bf16 v32, v67, v14
v_dot2c_f32_bf16 v33, v67, v2
v_dot2c_f32_bf16 v34, v68, v14
v_dot2c_f32_bf16 v35, v68, v2
v_dot2c_f32_bf16 v36, v69, v14
v_dot2c_f32_bf16 v37, v69, v2
s_add_u32 s54, s54, 196608
s_waitcnt vmcnt(2)
buffer_load_dwordx4 v[90:93], v1, s[24:27], s54 offen offset:0 nt
s_waitcnt vmcnt(5)
v_dot2c_f32_bf16 v38, v70, v14
v_dot2c_f32_bf16 v39, v70, v2
v_dot2c_f32_bf16 v40, v71, v14
v_dot2c_f32_bf16 v41, v71, v2
v_dot2c_f32_bf16 v42, v72, v14
v_dot2c_f32_bf16 v43, v72, v2
v_dot2c_f32_bf16 v44, v73, v14
v_dot2c_f32_bf16 v45, v73, v2
s_waitcnt vmcnt(4)
v_dot2c_f32_bf16 v46, v74, v14
v_dot2c_f32_bf16 v47, v74, v2
v_dot2c_f32_bf16 v48, v75, v14
v_dot2c_f32_bf16 v49, v75, v2
v_dot2c_f32_bf16 v50, v76, v14
v_dot2c_f32_bf16 v51, v76, v2
v_dot2c_f32_bf16 v52, v77, v14
v_dot2c_f32_bf16 v53, v77, v2
s_waitcnt vmcnt(2)
buffer_load_dwordx4 v[94:97], v1, s[24:27], s54 offen offset:128 nt
s_waitcnt vmcnt(4)
v_lshlrev_b32 v2, 16, v15
v_dot2c_f32_bf16 v30, v78, v15
v_dot2c_f32_bf16 v31, v78, v2
v_dot2c_f32_bf16 v32, v79, v15
v_dot2c_f32_bf16 v33, v79, v2
v_dot2c_f32_bf16 v34, v80, v15
v_dot2c_f32_bf16 v35, v80, v2
v_dot2c_f32_bf16 v36, v81, v15
v_dot2c_f32_bf16 v37, v81, v2
s_waitcnt vmcnt(2)
buffer_load_dwordx4 v[98:101], v1, s[24:27], s54 offen offset:256 nt
s_waitcnt vmcnt(4)
v_dot2c_f32_bf16 v38, v82, v15
v_dot2c_f32_bf16 v39, v82, v2
v_dot2c_f32_bf16 v40, v83, v15
v_dot2c_f32_bf16 v41, v83, v2
v_dot2c_f32_bf16 v42, v84, v15
v_dot2c_f32_bf16 v43, v84, v2
v_dot2c_f32_bf16 v44, v85, v15
v_dot2c_f32_bf16 v45, v85, v2
s_lshl_b32 s101, s3, 6
s_add_u32 s101, s101, 0
v_add_u32 v3, s101, v0
v_mul_hi_u32 v4, v3, s57
v_mul_u32_u24 v5, 10, v4
v_sub_u32 v5, v3, v5
v_mul_u32_u24 v4, 1280, v4
v_lshl_add_u32 v4, v5, 4, v4
s_lshl_b32 s101, s101, 4
s_add_u32 m0, s101, 9216
s_waitcnt vmcnt(2)
buffer_load_dwordx4 v4, s[32:35], s100 offen nt lds
s_waitcnt vmcnt(4)
v_dot2c_f32_bf16 v46, v86, v15
v_dot2c_f32_bf16 v47, v86, v2
v_dot2c_f32_bf16 v48, v87, v15
v_dot2c_f32_bf16 v49, v87, v2
v_dot2c_f32_bf16 v50, v88, v15
v_dot2c_f32_bf16 v51, v88, v2
v_dot2c_f32_bf16 v52, v89, v15
v_dot2c_f32_bf16 v53, v89, v2
s_add_u32 s54, s54, 196608
s_waitcnt vmcnt(2)
buffer_load_dwordx4 v[102:105], v1, s[24:27], s54 offen offset:0 nt
s_waitcnt vmcnt(4)
v_lshlrev_b32 v2, 16, v16
v_dot2c_f32_bf16 v30, v90, v16
v_dot2c_f32_bf16 v31, v90, v2
v_dot2c_f32_bf16 v32, v91, v16
v_dot2c_f32_bf16 v33, v91, v2
v_dot2c_f32_bf16 v34, v92, v16
v_dot2c_f32_bf16 v35, v92, v2
v_dot2c_f32_bf16 v36, v93, v16
v_dot2c_f32_bf16 v37, v93, v2
s_waitcnt vmcnt(2)
buffer_load_dwordx4 v[106:109], v1, s[24:27], s54 offen offset:128 nt
s_waitcnt vmcnt(4)
v_dot2c_f32_bf16 v38, v94, v16
v_dot2c_f32_bf16 v39, v94, v2
v_dot2c_f32_bf16 v40, v95, v16
v_dot2c_f32_bf16 v41, v95, v2
v_dot2c_f32_bf16 v42, v96, v16
v_dot2c_f32_bf16 v43, v96, v2
v_dot2c_f32_bf16 v44, v97, v16
v_dot2c_f32_bf16 v45, v97, v2
s_waitcnt vmcnt(2)
buffer_load_dwordx4 v[110:113], v1, s[24:27], s54 offen offset:256 nt
s_waitcnt vmcnt(4)
v_dot2c_f32_bf16 v46, v98, v16
v_dot2c_f32_bf16 v47, v98, v2
v_dot2c_f32_bf16 v48, v99, v16
v_dot2c_f32_bf16 v49, v99, v2
v_dot2c_f32_bf16 v50, v100, v16
v_dot2c_f32_bf16 v51, v100, v2
v_dot2c_f32_bf16 v52, v101, v16
v_dot2c_f32_bf16 v53, v101, v2
s_lshl_b32 s101, s3, 6
s_add_u32 s101, s101, 512
v_add_u32 v3, s101, v0
v_mul_hi_u32 v4, v3, s57
v_mul_u32_u24 v5, 10, v4
v_sub_u32 v5, v3, v5
v_mul_u32_u24 v4, 1280, v4
v_lshl_add_u32 v4, v5, 4, v4
s_lshl_b32 s101, s101, 4
s_add_u32 m0, s101, 9216
s_waitcnt vmcnt(2)
buffer_load_dwordx4 v4, s[32:35], s100 offen nt lds
s_waitcnt vmcnt(3)
v_lshlrev_b32 v2, 16, v17
v_dot2c_f32_bf16 v30, v102, v17
v_dot2c_f32_bf16 v31, v102, v2
v_dot2c_f32_bf16 v32, v103, v17
v_dot2c_f32_bf16 v33, v103, v2
v_dot2c_f32_bf16 v34, v104, v17
v_dot2c_f32_bf16 v35, v104, v2
v_dot2c_f32_bf16 v36, v105, v17
v_dot2c_f32_bf16 v37, v105, v2
s_add_u32 s54, s54, 196608
s_waitcnt vmcnt(2)
buffer_load_dwordx4 v[114:117], v1, s[24:27], s54 offen offset:0 nt
s_waitcnt vmcnt(3)
v_dot2c_f32_bf16 v38, v106, v17
v_dot2c_f32_bf16 v39, v106, v2
v_dot2c_f32_bf16 v40, v107, v17
v_dot2c_f32_bf16 v41, v107, v2
v_dot2c_f32_bf16 v42, v108, v17
v_dot2c_f32_bf16 v43, v108, v2
v_dot2c_f32_bf16 v44, v109, v17
v_dot2c_f32_bf16 v45, v109, v2
s_waitcnt vmcnt(2)
buffer_load_dwordx4 v[118:121], v1, s[24:27], s54 offen offset:128 nt
s_waitcnt vmcnt(3)
v_dot2c_f32_bf16 v46, v110, v17
v_dot2c_f32_bf16 v47, v110, v2
v_dot2c_f32_bf16 v48, v111, v17
v_dot2c_f32_bf16 v49, v111, v2
v_dot2c_f32_bf16 v50, v112, v17
v_dot2c_f32_bf16 v51, v112, v2
v_dot2c_f32_bf16 v52, v113, v17
v_dot2c_f32_bf16 v53, v113, v2
s_waitcnt vmcnt(2)
buffer_load_dwordx4 v[122:125], v1, s[24:27], s54 offen offset:256 nt
s_lshl_b32 s101, s3, 6
s_add_u32 s101, s101, 1024
v_add_u32 v3, s101, v0
v_mul_hi_u32 v4, v3, s57
v_mul_u32_u24 v5, 10, v4
v_sub_u32 v5, v3, v5
v_mul_u32_u24 v4, 1280, v4
v_lshl_add_u32 v4, v5, 4, v4
s_lshl_b32 s101, s101, 4
s_add_u32 m0, s101, 9216
s_waitcnt vmcnt(2)
buffer_load_dwordx4 v4, s[32:35], s100 offen nt lds
s_waitcnt vmcnt(3)
v_lshlrev_b32 v2, 16, v18
v_dot2c_f32_bf16 v30, v114, v18
v_dot2c_f32_bf16 v31, v114, v2
v_dot2c_f32_bf16 v32, v115, v18
v_dot2c_f32_bf16 v33, v115, v2
v_dot2c_f32_bf16 v34, v116, v18
v_dot2c_f32_bf16 v35, v116, v2
v_dot2c_f32_bf16 v36, v117, v18
v_dot2c_f32_bf16 v37, v117, v2
s_add_u32 s54, s54, 196608
s_waitcnt vmcnt(2)
buffer_load_dwordx4 v[126:129], v1, s[24:27], s54 offen offset:0 nt
s_waitcnt vmcnt(3)
v_dot2c_f32_bf16 v38, v118, v18
v_dot2c_f32_bf16 v39, v118, v2
v_dot2c_f32_bf16 v40, v119, v18
v_dot2c_f32_bf16 v41, v119, v2
v_dot2c_f32_bf16 v42, v120, v18
v_dot2c_f32_bf16 v43, v120, v2
v_dot2c_f32_bf16 v44, v121, v18
v_dot2c_f32_bf16 v45, v121, v2
s_waitcnt vmcnt(2)
buffer_load_dwordx4 v[130:133], v1, s[24:27], s54 offen offset:128 nt
s_waitcnt vmcnt(3)
v_dot2c_f32_bf16 v46, v122, v18
v_dot2c_f32_bf16 v47, v122, v2
v_dot2c_f32_bf16 v48, v123, v18
v_dot2c_f32_bf16 v49, v123, v2
v_dot2c_f32_bf16 v50, v124, v18
v_dot2c_f32_bf16 v51, v124, v2
v_dot2c_f32_bf16 v52, v125, v18
v_dot2c_f32_bf16 v53, v125, v2
s_waitcnt vmcnt(2)
buffer_load_dwordx4 v[134:137], v1, s[24:27], s54 offen offset:256 nt
s_and_b32 s101, s3, 3
s_cmp_eq_u32 s101, 0
s_cbranch_scc1 L_wo1
s_lshr_b32 s101, s3, 2
s_sub_u32 s101, s3, s101
s_add_u32 s101, s101, 23
s_lshl_b32 s101, s101, 6
v_add_u32 v3, s101, v0
v_mul_hi_u32 v4, v3, s57
v_mul_u32_u24 v5, 10, v4
v_sub_u32 v5, v3, v5
v_mul_u32_u24 v4, 1280, v4
v_lshl_add_u32 v4, v5, 4, v4
s_lshl_b32 s101, s101, 4
s_add_u32 m0, s101, 9216
s_waitcnt vmcnt(2)
buffer_load_dwordx4 v4, s[32:35], s100 offen nt lds
L_wo1:
s_add_u32 s54, s54, 196608
s_waitcnt vmcnt(2)
buffer_load_dwordx4 v[138:141], v1, s[24:27], s54 offen offset:0 nt
s_waitcnt vmcnt(3)
v_lshlrev_b32 v2, 16, v19
v_dot2c_f32_bf16 v30, v126, v19
v_dot2c_f32_bf16 v31, v126, v2
v_dot2c_f32_bf16 v32, v127, v19
v_dot2c_f32_bf16 v33, v127, v2
v_dot2c_f32_bf16 v34, v128, v19
v_dot2c_f32_bf16 v35, v128, v2
v_dot2c_f32_bf16 v36, v129, v19
v_dot2c_f32_bf16 v37, v129, v2
s_waitcnt vmcnt(2)
buffer_load_dwordx4 v[142:145], v1, s[24:27], s54 offen offset:128 nt
s_waitcnt vmcnt(3)
v_dot2c_f32_bf16 v38, v130, v19
v_dot2c_f32_bf16 v39, v130, v2
v_dot2c_f32_bf16 v40, v131, v19
v_dot2c_f32_bf16 v41, v131, v2
v_dot2c_f32_bf16 v42, v132, v19
v_dot2c_f32_bf16 v43, v132, v2
v_dot2c_f32_bf16 v44, v133, v19
v_dot2c_f32_bf16 v45, v133, v2
s_waitcnt vmcnt(2)
buffer_load_dwordx4 v[146:149], v1, s[24:27], s54 offen offset:256 nt
s_waitcnt vmcnt(3)
v_dot2c_f32_bf16 v46, v134, v19
v_dot2c_f32_bf16 v47, v134, v2
v_dot2c_f32_bf16 v48, v135, v19
v_dot2c_f32_bf16 v49, v135, v2
v_dot2c_f32_bf16 v50, v136, v19
v_dot2c_f32_bf16 v51, v136, v2
v_dot2c_f32_bf16 v52, v137, v19
v_dot2c_f32_bf16 v53, v137, v2
s_add_u32 s54, s54, 196608
s_waitcnt vmcnt(2)
buffer_load_dwordx4 v[150:153], v1, s[24:27], s54 offen offset:0 nt
s_waitcnt vmcnt(3)
v_lshlrev_b32 v2, 16, v20
v_dot2c_f32_bf16 v30, v138, v20
v_dot2c_f32_bf16 v31, v138, v2
v_dot2c_f32_bf16 v32, v139, v20
v_dot2c_f32_bf16 v33, v139, v2
v_dot2c_f32_bf16 v34, v140, v20
v_dot2c_f32_bf16 v35, v140, v2
v_dot2c_f32_bf16 v36, v141, v20
v_dot2c_f32_bf16 v37, v141, v2
s_waitcnt vmcnt(2)
buffer_load_dwordx4 v[154:157], v1, s[24:27], s54 offen offset:128 nt
s_waitcnt vmcnt(3)
v_dot2c_f32_bf16 v38, v142, v20
v_dot2c_f32_bf16 v39, v142, v2
v_dot2c_f32_bf16 v40, v143, v20
v_dot2c_f32_bf16 v41, v143, v2
v_dot2c_f32_bf16 v42, v144, v20
v_dot2c_f32_bf16 v43, v144, v2
v_dot2c_f32_bf16 v44, v145, v20
v_dot2c_f32_bf16 v45, v145, v2
s_waitcnt vmcnt(2)
buffer_load_dwordx4 v[158:161], v1, s[24:27], s54 offen offset:256 nt
s_waitcnt vmcnt(3)
v_dot2c_f32_bf16 v46, v146, v20
v_dot2c_f32_bf16 v47, v146, v2
v_dot2c_f32_bf16 v48, v147, v20
v_dot2c_f32_bf16 v49, v147, v2
v_dot2c_f32_bf16 v50, v148, v20
v_dot2c_f32_bf16 v51, v148, v2
v_dot2c_f32_bf16 v52, v149, v20
v_dot2c_f32_bf16 v53, v149, v2
s_add_u32 s54, s54, 196608
s_waitcnt vmcnt(2)
buffer_load_dwordx4 v[162:165], v1, s[24:27], s54 offen offset:0 nt
s_waitcnt vmcnt(3)
v_lshlrev_b32 v2, 16, v21
v_dot2c_f32_bf16 v30, v150, v21
v_dot2c_f32_bf16 v31, v150, v2
v_dot2c_f32_bf16 v32, v151, v21
v_dot2c_f32_bf16 v33, v151, v2
v_dot2c_f32_bf16 v34, v152, v21
v_dot2c_f32_bf16 v35, v152, v2
v_dot2c_f32_bf16 v36, v153, v21
v_dot2c_f32_bf16 v37, v153, v2
s_waitcnt vmcnt(2)
buffer_load_dwordx4 v[166:169], v1, s[24:27], s54 offen offset:128 nt
s_waitcnt vmcnt(3)
v_dot2c_f32_bf16 v38, v154, v21
v_dot2c_f32_bf16 v39, v154, v2
v_dot2c_f32_bf16 v40, v155, v21
v_dot2c_f32_bf16 v41, v155, v2
v_dot2c_f32_bf16 v42, v156, v21
v_dot2c_f32_bf16 v43, v156, v2
v_dot2c_f32_bf16 v44, v157, v21
v_dot2c_f32_bf16 v45, v157, v2
s_waitcnt vmcnt(2)
buffer_load_dwordx4 v[170:173], v1, s[24:27], s54 offen offset:256 nt
s_waitcnt vmcnt(3)
v_dot2c_f32_bf16 v46, v158, v21
v_dot2c_f32_bf16 v47, v158, v2
v_dot2c_f32_bf16 v48, v159, v21
v_dot2c_f32_bf16 v49, v159, v2
v_dot2c_f32_bf16 v50, v160, v21
v_dot2c_f32_bf16 v51, v160, v2
v_dot2c_f32_bf16 v52, v161, v21
v_dot2c_f32_bf16 v53, v161, v2
s_add_u32 s54, s54, 196608
s_waitcnt vmcnt(2)
buffer_load_dwordx4 v[174:177], v1, s[24:27], s54 offen offset:0 nt
s_waitcnt vmcnt(3)
v_lshlrev_b32 v2, 16, v22
v_dot2c_f32_bf16 v30, v162, v22
v_dot2c_f32_bf16 v31, v162, v2
v_dot2c_f32_bf16 v32, v163, v22
v_dot2c_f32_bf16 v33, v163, v2
v_dot2c_f32_bf16 v34, v164, v22
v_dot2c_f32_bf16 v35, v164, v2
v_dot2c_f32_bf16 v36, v165, v22
v_dot2c_f32_bf16 v37, v165, v2
s_waitcnt vmcnt(2)
buffer_load_dwordx4 v[178:181], v1, s[24:27], s54 offen offset:128 nt
s_waitcnt vmcnt(3)
v_dot2c_f32_bf16 v38, v166, v22
v_dot2c_f32_bf16 v39, v166, v2
v_dot2c_f32_bf16 v40, v167, v22
v_dot2c_f32_bf16 v41, v167, v2
v_dot2c_f32_bf16 v42, v168, v22
v_dot2c_f32_bf16 v43, v168, v2
v_dot2c_f32_bf16 v44, v169, v22
v_dot2c_f32_bf16 v45, v169, v2
s_waitcnt vmcnt(2)
buffer_load_dwordx4 v[182:185], v1, s[24:27], s54 offen offset:256 nt
s_waitcnt vmcnt(3)
v_dot2c_f32_bf16 v46, v170, v22
v_dot2c_f32_bf16 v47, v170, v2
v_dot2c_f32_bf16 v48, v171, v22
v_dot2c_f32_bf16 v49, v171, v2
v_dot2c_f32_bf16 v50, v172, v22
v_dot2c_f32_bf16 v51, v172, v2
v_dot2c_f32_bf16 v52, v173, v22
v_dot2c_f32_bf16 v53, v173, v2
s_add_u32 s54, s54, 196608
s_waitcnt vmcnt(2)
buffer_load_dwordx4 v[186:189], v1, s[24:27], s54 offen offset:0 nt
s_waitcnt vmcnt(3)
v_lshlrev_b32 v2, 16, v23
v_dot2c_f32_bf16 v30, v174, v23
v_dot2c_f32_bf16 v31, v174, v2
v_dot2c_f32_bf16 v32, v175, v23
v_dot2c_f32_bf16 v33, v175, v2
v_dot2c_f32_bf16 v34, v176, v23
v_dot2c_f32_bf16 v35, v176, v2
v_dot2c_f32_bf16 v36, v177, v23
v_dot2c_f32_bf16 v37, v177, v2
s_waitcnt vmcnt(2)
buffer_load_dwordx4 v[190:193], v1, s[24:27], s54 offen offset:128 nt
s_waitcnt vmcnt(3)
v_dot2c_f32_bf16 v38, v178, v23
v_dot2c_f32_bf16 v39, v178, v2
v_dot2c_f32_bf16 v40, v179, v23
v_dot2c_f32_bf16 v41, v179, v2
v_dot2c_f32_bf16 v42, v180, v23
v_dot2c_f32_bf16 v43, v180, v2
v_dot2c_f32_bf16 v44, v181, v23
v_dot2c_f32_bf16 v45, v181, v2
s_waitcnt vmcnt(2)
buffer_load_dwordx4 v[194:197], v1, s[24:27], s54 offen offset:256 nt
s_waitcnt vmcnt(3)
v_dot2c_f32_bf16 v46, v182, v23
v_dot2c_f32_bf16 v47, v182, v2
v_dot2c_f32_bf16 v48, v183, v23
v_dot2c_f32_bf16 v49, v183, v2
v_dot2c_f32_bf16 v50, v184, v23
v_dot2c_f32_bf16 v51, v184, v2
v_dot2c_f32_bf16 v52, v185, v23
v_dot2c_f32_bf16 v53, v185, v2
s_add_u32 s54, s54, 196608
s_waitcnt vmcnt(2)
buffer_load_dwordx4 v[198:201], v1, s[24:27], s54 offen offset:0 nt
s_waitcnt vmcnt(3)
v_lshlrev_b32 v2, 16, v24
v_dot2c_f32_bf16 v30, v186, v24
v_dot2c_f32_bf16 v31, v186, v2
v_dot2c_f32_bf16 v32, v187, v24
v_dot2c_f32_bf16 v33, v187, v2
v_dot2c_f32_bf16 v34, v188, v24
v_dot2c_f32_bf16 v35, v188, v2
v_dot2c_f32_bf16 v36, v189, v24
v_dot2c_f32_bf16 v37, v189, v2
s_waitcnt vmcnt(2)
buffer_load_dwordx4 v[202:205], v1, s[24:27], s54 offen offset:128 nt
s_waitcnt vmcnt(3)
v_dot2c_f32_bf16 v38, v190, v24
v_dot2c_f32_bf16 v39, v190, v2
v_dot2c_f32_bf16 v40, v191, v24
v_dot2c_f32_bf16 v41, v191, v2
v_dot2c_f32_bf16 v42, v192, v24
v_dot2c_f32_bf16 v43, v192, v2
v_dot2c_f32_bf16 v44, v193, v24
v_dot2c_f32_bf16 v45, v193, v2
s_waitcnt vmcnt(2)
buffer_load_dwordx4 v[206:209], v1, s[24:27], s54 offen offset:256 nt
s_waitcnt vmcnt(3)
v_dot2c_f32_bf16 v46, v194, v24
v_dot2c_f32_bf16 v47, v194, v2
v_dot2c_f32_bf16 v48, v195, v24
v_dot2c_f32_bf16 v49, v195, v2
v_dot2c_f32_bf16 v50, v196, v24
v_dot2c_f32_bf16 v51, v196, v2
v_dot2c_f32_bf16 v52, v197, v24
v_dot2c_f32_bf16 v53, v197, v2
s_add_u32 s54, s54, 196608
s_waitcnt vmcnt(5)
buffer_load_dwordx4 v[210:213], v1, s[24:27], s54 offen offset:0 nt
s_waitcnt vmcnt(5)
buffer_load_dwordx4 v[214:217], v1, s[24:27], s54 offen offset:128 nt
s_waitcnt vmcnt(5)
buffer_load_dwordx4 v[218:221], v1, s[24:27], s54 offen offset:256 nt
s_add_u32 s54, s54, 196608
s_waitcnt vmcnt(5)
buffer_load_dwordx4 v[222:225], v1, s[24:27], s54 offen offset:0 nt
s_waitcnt vmcnt(6)
v_lshlrev_b32 v2, 16, v25
v_dot2c_f32_bf16 v30, v198, v25
v_dot2c_f32_bf16 v31, v198, v2
v_dot2c_f32_bf16 v32, v199, v25
v_dot2c_f32_bf16 v33, v199, v2
v_dot2c_f32_bf16 v34, v200, v25
v_dot2c_f32_bf16 v35, v200, v2
v_dot2c_f32_bf16 v36, v201, v25
v_dot2c_f32_bf16 v37, v201, v2
s_waitcnt vmcnt(5)
buffer_load_dwordx4 v[226:229], v1, s[24:27], s54 offen offset:128 nt
s_waitcnt vmcnt(6)
v_dot2c_f32_bf16 v38, v202, v25
v_dot2c_f32_bf16 v39, v202, v2
v_dot2c_f32_bf16 v40, v203, v25
v_dot2c_f32_bf16 v41, v203, v2
v_dot2c_f32_bf16 v42, v204, v25
v_dot2c_f32_bf16 v43, v204, v2
v_dot2c_f32_bf16 v44, v205, v25
v_dot2c_f32_bf16 v45, v205, v2
s_waitcnt vmcnt(5)
buffer_load_dwordx4 v[230:233], v1, s[24:27], s54 offen offset:256 nt
s_waitcnt vmcnt(6)
v_dot2c_f32_bf16 v46, v206, v25
v_dot2c_f32_bf16 v47, v206, v2
v_dot2c_f32_bf16 v48, v207, v25
v_dot2c_f32_bf16 v49, v207, v2
v_dot2c_f32_bf16 v50, v208, v25
v_dot2c_f32_bf16 v51, v208, v2
v_dot2c_f32_bf16 v52, v209, v25
v_dot2c_f32_bf16 v53, v209, v2
s_add_u32 s54, s54, 196608
s_waitcnt vmcnt(5)
buffer_load_dwordx4 v[234:237], v1, s[24:27], s54 offen offset:0 nt
s_waitcnt vmcnt(6)
v_lshlrev_b32 v2, 16, v26
v_dot2c_f32_bf16 v30, v210, v26
v_dot2c_f32_bf16 v31, v210, v2
v_dot2c_f32_bf16 v32, v211, v26
v_dot2c_f32_bf16 v33, v211, v2
v_dot2c_f32_bf16 v34, v212, v26
v_dot2c_f32_bf16 v35, v212, v2
v_dot2c_f32_bf16 v36, v213, v26
v_dot2c_f32_bf16 v37, v213, v2
s_waitcnt vmcnt(5)
buffer_load_dwordx4 v[238:241], v1, s[24:27], s54 offen offset:128 nt
s_waitcnt vmcnt(6)
v_dot2c_f32_bf16 v38, v214, v26
v_dot2c_f32_bf16 v39, v214, v2
v_dot2c_f32_bf16 v40, v215, v26
v_dot2c_f32_bf16 v41, v215, v2
v_dot2c_f32_bf16 v42, v216, v26
v_dot2c_f32_bf16 v43, v216, v2
v_dot2c_f32_bf16 v44, v217, v26
v_dot2c_f32_bf16 v45, v217, v2
s_waitcnt vmcnt(5)
buffer_load_dwordx4 v[242:245], v1, s[24:27], s54 offen offset:256 nt
s_waitcnt vmcnt(6)
v_dot2c_f32_bf16 v46, v218, v26
v_dot2c_f32_bf16 v47, v218, v2
v_dot2c_f32_bf16 v48, v219, v26
v_dot2c_f32_bf16 v49, v219, v2
v_dot2c_f32_bf16 v50, v220, v26
v_dot2c_f32_bf16 v51, v220, v2
v_dot2c_f32_bf16 v52, v221, v26
v_dot2c_f32_bf16 v53, v221, v2
s_waitcnt vmcnt(5)
v_lshlrev_b32 v2, 16, v27
v_dot2c_f32_bf16 v30, v222, v27
v_dot2c_f32_bf16 v31, v222, v2
v_dot2c_f32_bf16 v32, v223, v27
v_dot2c_f32_bf16 v33, v223, v2
v_dot2c_f32_bf16 v34, v224, v27
v_dot2c_f32_bf16 v35, v224, v2
v_dot2c_f32_bf16 v36, v225, v27
v_dot2c_f32_bf16 v37, v225, v2
s_waitcnt vmcnt(4)
v_dot2c_f32_bf16 v38, v226, v27
v_dot2c_f32_bf16 v39, v226, v2
v_dot2c_f32_bf16 v40, v227, v27
v_dot2c_f32_bf16 v41, v227, v2
v_dot2c_f32_bf16 v42, v228, v27
v_dot2c_f32_bf16 v43, v228, v2
v_dot2c_f32_bf16 v44, v229, v27
v_dot2c_f32_bf16 v45, v229, v2
s_waitcnt vmcnt(3)
v_dot2c_f32_bf16 v46, v230, v27
v_dot2c_f32_bf16 v47, v230, v2
v_dot2c_f32_bf16 v48, v231, v27
v_dot2c_f32_bf16 v49, v231, v2
v_dot2c_f32_bf16 v50, v232, v27
v_dot2c_f32_bf16 v51, v232, v2
v_dot2c_f32_bf16 v52, v233, v27
v_dot2c_f32_bf16 v53, v233, v2
s_waitcnt vmcnt(2)
v_lshlrev_b32 v2, 16, v28
v_dot2c_f32_bf16 v30, v234, v28
v_dot2c_f32_bf16 v31, v234, v2
v_dot2c_f32_bf16 v32, v235, v28
v_dot2c_f32_bf16 v33, v235, v2
v_dot2c_f32_bf16 v34, v236, v28
v_dot2c_f32_bf16 v35, v236, v2
v_dot2c_f32_bf16 v36, v237, v28
v_dot2c_f32_bf16 v37, v237, v2
s_waitcnt vmcnt(1)
v_dot2c_f32_bf16 v38, v238, v28
v_dot2c_f32_bf16 v39, v238, v2
v_dot2c_f32_bf16 v40, v239, v28
v_dot2c_f32_bf16 v41, v239, v2
v_dot2c_f32_bf16 v42, v240, v28
v_dot2c_f32_bf16 v43, v240, v2
v_dot2c_f32_bf16 v44, v241, v28
v_dot2c_f32_bf16 v45, v241, v2
s_waitcnt vmcnt(0)
v_dot2c_f32_bf16 v46, v242, v28
v_dot2c_f32_bf16 v47, v242, v2
v_dot2c_f32_bf16 v48, v243, v28
v_dot2c_f32_bf16 v49, v243, v2
v_dot2c_f32_bf16 v50, v244, v28
v_dot2c_f32_bf16 v51, v244, v2
v_dot2c_f32_bf16 v52, v245, v28
v_dot2c_f32_bf16 v53, v245, v2
v_mov_b32 v9, s56
L_tail:
s_nop 2
v_permlane32_swap_b32 v30, v34
v_permlane32_swap_b32 v31, v35
v_permlane32_swap_b32 v32, v36
v_permlane32_swap_b32 v33, v37
v_permlane32_swap_b32 v38, v42
v_permlane32_swap_b32 v39, v43
v_permlane32_swap_b32 v40, v44
v_permlane32_swap_b32 v41, v45
v_permlane32_swap_b32 v46, v50
v_permlane32_swap_b32 v47, v51
v_permlane32_swap_b32 v48, v52
v_permlane32_swap_b32 v49, v53
v_add_f32 v30, v30, v34
v_add_f32 v31, v31, v35
v_add_f32 v32, v32, v36
v_add_f32 v33, v33, v37
v_add_f32 v38, v38, v42
v_add_f32 v39, v39, v43
v_add_f32 v40, v40, v44
v_add_f32 v41, v41, v45
v_add_f32 v46, v46, v50
v_add_f32 v47, v47, v51
v_add_f32 v48, v48, v52
v_add_f32 v49, v49, v53
s_nop 1
v_permlane16_swap_b32 v30, v32
v_permlane16_swap_b32 v31, v33
v_permlane16_swap_b32 v38, v40
v_permlane16_swap_b32 v39, v41
v_permlane16_swap_b32 v46, v48
v_permlane16_swap_b32 v47, v49
v_add_f32 v30, v30, v32
v_add_f32 v31, v31, v33
v_add_f32 v38, v38, v40
v_add_f32 v39, v39, v41
v_add_f32 v46, v46, v48
v_add_f32 v47, v47, v49
s_nop 1
v_add_f32_dpp v30, v30, v30 row_ror:8 row_mask:0xf bank_mask:0xf
v_add_f32_dpp v31, v31, v31 row_ror:8 row_mask:0xf bank_mask:0xf
v_add_f32_dpp v38, v38, v38 row_ror:8 row_mask:0xf bank_mask:0xf
v_add_f32_dpp v39, v39, v39 row_ror:8 row_mask:0xf bank_mask:0xf
v_add_f32_dpp v46, v46, v46 row_ror:8 row_mask:0xf bank_mask:0xf
v_add_f32_dpp v47, v47, v47 row_ror:8 row_mask:0xf bank_mask:0xf
v_cndmask_b32 v6, v30, v39, s[58:59]
v_cndmask_b32 v7, v31, v46, s[58:59]
v_cndmask_b32 v8, v38, v47, s[58:59]
ds_write_b128 v11, v[6:9] offset:1024
s_waitcnt vmcnt(0) lgkmcnt(0)
s_barrier
s_cmp_ge_u32 s3, 5
s_cbranch_scc1 L_done_st
s_cmp_eq_u32 s3, 0
s_cbranch_scc1 L_w0tail
v_lshrrev_b32 v2, 4, v0
v_lshlrev_b32 v2, 3, v2
v_bfe_u32 v4, v0, 2, 2
v_add_u32 v2, v2, v4
v_mul_u32_u24 v2, 160, v2
v_and_b32 v4, 3, v0
v_lshl_add_u32 v2, v4, 3, v2
s_lshl_b32 s50, s3, 5
v_add_u32 v2, s50, v2
ds_read_b64_tr_b16 v[150:151], v2 offset:9216
ds_read_b64_tr_b16 v[152:153], v2 offset:9856
ds_read_b64_tr_b16 v[154:155], v2 offset:14336
ds_read_b64_tr_b16 v[156:157], v2 offset:14976
ds_read_b64_tr_b16 v[158:159], v2 offset:19456
ds_read_b64_tr_b16 v[160:161], v2 offset:20096
ds_read_b64_tr_b16 v[162:163], v2 offset:24576
ds_read_b64_tr_b16 v[164:165], v2 offset:25216
ds_read_b64_tr_b16 v[166:167], v2 offset:29696
ds_read_b64_tr_b16 v[168:169], v2 offset:30336
ds_read_b64_tr_b16 v[170:171], v2 offset:34816
ds_read_b64_tr_b16 v[172:173], v2 offset:35456
v_lshrrev_b32 v32, 4, v0
v_lshlrev_b32 v32, 4, v32
v_mov_b32 v194, 0
v_mov_b32 v195, 0
v_mov_b32 v196, 0
v_mov_b32 v197, 0
s_mul_i32 s42, s45, 5
s_add_u32 s42, s42, s3
s_lshl_b32 s42, s42, 12
s_add_u32 s42, s42, 598016
s_lshl_b32 s43, s44, 7
s_add_u32 s43, s43, s42
v_and_b32 v4, 1, v0
v_lshlrev_b32 v33, 1, v32
v_lshl_add_u32 v33, v4, 4, v33
v_cmp_eq_u32 s[16:17], 1, v4
v_mov_b32 v200, s56
v_mov_b32 v201, s56
s_branch L_bar3
L_w0tail:
ds_read_b128 v[54:57], v10 offset:1024
ds_read_b128 v[58:61], v10 offset:2048
ds_read_b128 v[62:65], v10 offset:3072
ds_read_b128 v[66:69], v10 offset:4096
ds_read_b128 v[70:73], v10 offset:5120
ds_read_b128 v[74:77], v10 offset:6144
ds_read_b128 v[78:81], v10 offset:7168
ds_read_b128 v[82:85], v10 offset:8192
s_lshl_b32 s49, s55, 10
s_add_u32 s49, s49, 327680
s_lshl_b32 s47, s44, 13
s_add_u32 s47, s47, 327680
s_add_u32 s48, s47, 4096
s_add_u32 s50, s49, 434176
s_add_u32 s36, s47, 434176
s_add_u32 s37, s36, 4096
s_waitcnt lgkmcnt(4)
v_mul_f32 v6, s4, v54
v_mul_f32 v7, s4, v55
v_mul_f32 v8, s4, v56
v_fmac_f32 v6, s5, v58
v_fmac_f32 v7, s5, v59
v_fmac_f32 v8, s5, v60
v_fmac_f32 v6, s6, v62
v_fmac_f32 v7, s6, v63
v_fmac_f32 v8, s6, v64
v_fmac_f32 v6, s7, v66
v_fmac_f32 v7, s7, v67
v_fmac_f32 v8, s7, v68
s_waitcnt lgkmcnt(0)
v_mul_f32 v54, s8, v70
v_mul_f32 v55, s8, v71
v_mul_f32 v56, s8, v72
v_fmac_f32 v54, s9, v74
v_fmac_f32 v55, s9, v75
v_fmac_f32 v56, s9, v76
v_fmac_f32 v54, s10, v78
v_fmac_f32 v55, s10, v79
v_fmac_f32 v56, s10, v80
v_fmac_f32 v54, s11, v82
v_fmac_f32 v55, s11, v83
v_fmac_f32 v56, s11, v84
v_add_f32 v6, v6, v54
v_add_f32 v7, v7, v55
v_add_f32 v8, v8, v56
buffer_store_dwordx4 v[6:9], v10, s[28:31], s50 offen
buffer_store_dwordx4 v[6:9], v10, s[28:31], s49 offen sc1
buffer_load_dwordx4 v[54:57], v10, s[28:31], s36 offen offset:0 sc1
buffer_load_dwordx4 v[58:61], v10, s[28:31], s36 offen offset:1024 sc1
buffer_load_dwordx4 v[62:65], v10, s[28:31], s36 offen offset:2048 sc1
buffer_load_dwordx4 v[66:69], v10, s[28:31], s36 offen offset:3072 sc1
buffer_load_dwordx4 v[70:73], v10, s[28:31], s37 offen offset:0 sc1
buffer_load_dwordx4 v[74:77], v10, s[28:31], s37 offen offset:1024 sc1
buffer_load_dwordx4 v[78:81], v10, s[28:31], s37 offen offset:2048 sc1
buffer_load_dwordx4 v[82:85], v10, s[28:31], s37 offen offset:3072 sc1
s_mov_b32 s51, 200000
v_lshrrev_b32 v2, 4, v0
v_lshlrev_b32 v2, 3, v2
v_bfe_u32 v4, v0, 2, 2
v_add_u32 v2, v2, v4
v_mul_u32_u24 v2, 160, v2
v_and_b32 v4, 3, v0
v_lshl_add_u32 v2, v4, 3, v2
s_lshl_b32 s50, s3, 5
v_add_u32 v2, s50, v2
ds_read_b64_tr_b16 v[150:151], v2 offset:9216
ds_read_b64_tr_b16 v[152:153], v2 offset:9856
ds_read_b64_tr_b16 v[154:155], v2 offset:14336
ds_read_b64_tr_b16 v[156:157], v2 offset:14976
ds_read_b64_tr_b16 v[158:159], v2 offset:19456
ds_read_b64_tr_b16 v[160:161], v2 offset:20096
ds_read_b64_tr_b16 v[162:163], v2 offset:24576
ds_read_b64_tr_b16 v[164:165], v2 offset:25216
ds_read_b64_tr_b16 v[166:167], v2 offset:29696
ds_read_b64_tr_b16 v[168:169], v2 offset:30336
ds_read_b64_tr_b16 v[170:171], v2 offset:34816
ds_read_b64_tr_b16 v[172:173], v2 offset:35456
v_and_b32 v30, 7, v0
v_lshlrev_b32 v30, 4, v30
v_lshrrev_b32 v4, 5, v0
v_lshl_add_u32 v30, v4, 3, v30
v_bfe_u32 v4, v0, 4, 1
v_lshl_add_u32 v30, v4, 2, v30
v_bfe_u32 v4, v0, 3, 1
v_lshl_add_u32 v31, v4, 1, v30
v_lshl_add_u32 v30, v4, 8, v30
v_lshrrev_b32 v32, 4, v0
v_lshlrev_b32 v32, 4, v32
v_mov_b32 v194, 0
v_mov_b32 v195, 0
v_mov_b32 v196, 0
v_mov_b32 v197, 0
s_mul_i32 s42, s45, 5
s_add_u32 s42, s42, s3
s_lshl_b32 s42, s42, 12
s_add_u32 s42, s42, 598016
s_lshl_b32 s43, s44, 7
s_add_u32 s43, s43, s42
v_and_b32 v4, 1, v0
v_lshlrev_b32 v33, 1, v32
v_lshl_add_u32 v33, v4, 4, v33
v_cmp_eq_u32 s[16:17], 1, v4
v_mov_b32 v200, s56
v_mov_b32 v201, s56
s_branch L_poll1c
L_poll1:
s_and_b32 s49, s51, 7
s_cmp_eq_u32 s49, 0
s_cbranch_scc1 L_poll1g
buffer_load_dwordx4 v[54:57], v10, s[28:31], s36 offen offset:0 sc1
buffer_load_dwordx4 v[58:61], v10, s[28:31], s36 offen offset:1024 sc1
buffer_load_dwordx4 v[62:65], v10, s[28:31], s36 offen offset:2048 sc1
buffer_load_dwordx4 v[66:69], v10, s[28:31], s36 offen offset:3072 sc1
buffer_load_dwordx4 v[70:73], v10, s[28:31], s37 offen offset:0 sc1
buffer_load_dwordx4 v[74:77], v10, s[28:31], s37 offen offset:1024 sc1
buffer_load_dwordx4 v[78:81], v10, s[28:31], s37 offen offset:2048 sc1
buffer_load_dwordx4 v[82:85], v10, s[28:31], s37 offen offset:3072 sc1
s_branch L_poll1c
L_poll1g:
buffer_load_dwordx4 v[54:57], v10, s[28:31], s47 offen offset:0 sc1
buffer_load_dwordx4 v[58:61], v10, s[28:31], s47 offen offset:1024 sc1
buffer_load_dwordx4 v[62:65], v10, s[28:31], s47 offen offset:2048 sc1
buffer_load_dwordx4 v[66:69], v10, s[28:31], s47 offen offset:3072 sc1
buffer_load_dwordx4 v[70:73], v10, s[28:31], s48 offen offset:0 sc1
buffer_load_dwordx4 v[74:77], v10, s[28:31], s48 offen offset:1024 sc1
buffer_load_dwordx4 v[78:81], v10, s[28:31], s48 offen offset:2048 sc1
buffer_load_dwordx4 v[82:85], v10, s[28:31], s48 offen offset:3072 sc1
L_poll1c:
s_waitcnt vmcnt(0)
v_xor_b32 v2, s56, v57
v_xor_b32 v4, s56, v61
v_xor_b32 v5, s56, v65
v_or3_b32 v2, v2, v4, v5
v_xor_b32 v4, s56, v69
v_xor_b32 v5, s56, v73
v_or3_b32 v2, v2, v4, v5
v_xor_b32 v4, s56, v77
v_xor_b32 v5, s56, v81
v_or3_b32 v2, v2, v4, v5
v_xor_b32 v4, s56, v85
v_or_b32 v2, v2, v4
v_cmp_ne_u32 vcc, 0, v2
s_cbranch_vccz L_got1
s_sub_u32 s51, s51, 1
s_cmp_lg_u32 s51, 0
s_cbranch_scc1 L_poll1
L_got1:
v_add_f32 v54, v54, v70
v_add_f32 v55, v55, v71
v_add_f32 v56, v56, v72
v_add_f32 v58, v58, v74
v_add_f32 v59, v59, v75
v_add_f32 v60, v60, v76
v_add_f32 v62, v62, v78
v_add_f32 v63, v63, v79
v_add_f32 v64, v64, v80
v_add_f32 v66, v66, v82
v_add_f32 v67, v67, v83
v_add_f32 v68, v68, v84
v_add_f32 v54, v54, v62
v_add_f32 v55, v55, v63
v_add_f32 v56, v56, v64
v_add_f32 v58, v58, v66
v_add_f32 v59, v59, v67
v_add_f32 v60, v60, v68
v_add_f32 v6, v54, v58
v_add_f32 v7, v55, v59
v_add_f32 v8, v56, v60
v_cndmask_b32 v2, v6, v7, s[58:59]
v_cndmask_b32 v4, v7, v8, s[58:59]
v_cndmask_b32 v5, v8, v6, s[58:59]
v_cvt_pk_bf16_f32 v2, v2, v4
v_cvt_pk_bf16_f32 v5, v5, v5
ds_write_b32 v30, v2 offset:384
ds_write_b16 v31, v5 offset:512
L_bar3:
s_waitcnt lgkmcnt(0)
s_barrier
ds_read_b128 v[54:57], v32 offset:384
ds_read_b128 v[58:61], v32 offset:448
ds_read_b128 v[62:65], v32 offset:512
ds_read_b128 v[66:69], v32 offset:576
ds_read_b128 v[70:73], v32 offset:640
ds_read_b128 v[74:77], v32 offset:704
s_waitcnt lgkmcnt(5)
v_mfma_f32_16x16x32_bf16 v[194:197], v[150:153], v[54:57], v[194:197]
s_waitcnt lgkmcnt(4)
v_mfma_f32_16x16x32_bf16 v[194:197], v[154:157], v[58:61], v[194:197]
s_waitcnt lgkmcnt(3)
v_mfma_f32_16x16x32_bf16 v[194:197], v[158:161], v[62:65], v[194:197]
s_waitcnt lgkmcnt(2)
v_mfma_f32_16x16x32_bf16 v[194:197], v[162:165], v[66:69], v[194:197]
s_waitcnt lgkmcnt(1)
v_mfma_f32_16x16x32_bf16 v[194:197], v[166:169], v[70:73], v[194:197]
s_waitcnt lgkmcnt(0)
v_mfma_f32_16x16x32_bf16 v[194:197], v[170:173], v[74:77], v[194:197]
s_mov_b32 exec_lo, 0x30003
s_mov_b32 exec_hi, 0x30003
s_nop 5
v_cndmask_b32 v198, v194, v196, s[16:17]
v_cndmask_b32 v199, v195, v197, s[16:17]
buffer_store_dwordx4 v[198:201], v33, s[28:31], s43 offen sc1
s_mov_b64 exec, -1
s_cmp_eq_u32 s44, 0
s_cbranch_scc0 L_done_st
buffer_load_dwordx4 v[102:105], v10, s[28:31], s42 offen offset:0 sc1
buffer_load_dwordx4 v[106:109], v10, s[28:31], s42 offen offset:1024 sc1
buffer_load_dwordx4 v[110:113], v10, s[28:31], s42 offen offset:2048 sc1
buffer_load_dwordx4 v[114:117], v10, s[28:31], s42 offen offset:3072 sc1
buffer_load_dwordx4 v[118:121], v10, s[28:31], s42 offen offset:0 sc1
buffer_load_dwordx4 v[122:125], v10, s[28:31], s42 offen offset:1024 sc1
buffer_load_dwordx4 v[126:129], v10, s[28:31], s42 offen offset:2048 sc1
buffer_load_dwordx4 v[130:133], v10, s[28:31], s42 offen offset:3072 sc1
s_mov_b32 s32, s14
s_mov_b32 s33, s15
s_mov_b32 s34, 1280
s_mov_b32 s35, 0x20000
s_mov_b32 s51, 200000
v_lshlrev_b32 v32, 2, v0
s_mul_i32 s47, s45, 160
s_lshl_b32 s48, s3, 5
s_add_u32 s47, s47, s48
L_poll2:
s_waitcnt vmcnt(4)
v_xor_b32 v2, s56, v105
v_xor_b32 v4, s56, v109
v_xor_b32 v5, s56, v113
v_or3_b32 v2, v2, v4, v5
v_xor_b32 v4, s56, v117
v_or_b32 v2, v2, v4
v_cmp_ne_u32 vcc, 0, v2
s_cbranch_vccz L_got2_0
buffer_load_dwordx4 v[102:105], v10, s[28:31], s42 offen offset:0 sc1
buffer_load_dwordx4 v[106:109], v10, s[28:31], s42 offen offset:1024 sc1
buffer_load_dwordx4 v[110:113], v10, s[28:31], s42 offen offset:2048 sc1
buffer_load_dwordx4 v[114:117], v10, s[28:31], s42 offen offset:3072 sc1
s_waitcnt vmcnt(4)
v_xor_b32 v2, s56, v121
v_xor_b32 v4, s56, v125
v_xor_b32 v5, s56, v129
v_or3_b32 v2, v2, v4, v5
v_xor_b32 v4, s56, v133
v_or_b32 v2, v2, v4
v_cmp_ne_u32 vcc, 0, v2
s_cbranch_vccz L_got2_1
buffer_load_dwordx4 v[118:121], v10, s[28:31], s42 offen offset:0 sc1
buffer_load_dwordx4 v[122:125], v10, s[28:31], s42 offen offset:1024 sc1
buffer_load_dwordx4 v[126:129], v10, s[28:31], s42 offen offset:2048 sc1
buffer_load_dwordx4 v[130:133], v10, s[28:31], s42 offen offset:3072 sc1
s_sub_u32 s51, s51, 1
s_cmp_lg_u32 s51, 0
s_cbranch_scc1 L_poll2
L_got2_0:
v_add_f32 v102, v102, v106
v_add_f32 v103, v103, v107
v_add_f32 v110, v110, v114
v_add_f32 v111, v111, v115
v_add_f32 v134, v102, v110
v_add_f32 v135, v103, v111
s_branch L_got2c
L_got2_1:
v_add_f32 v118, v118, v122
v_add_f32 v119, v119, v123
v_add_f32 v126, v126, v130
v_add_f32 v127, v127, v131
v_add_f32 v134, v118, v126
v_add_f32 v135, v119, v127
L_got2c:
s_or_b32 s48, s45, s3
s_cmp_eq_u32 s48, 0
s_cbranch_scc0 L_noepoch
v_mov_b32 v5, s56
s_mov_b64 exec, 1
buffer_store_dword v5, off, s[28:31], 0 offset:0 sc1
s_mov_b64 exec, -1
L_noepoch:
s_nop 1
v_add_f32_dpp v134, v134, v134 row_ror:8 row_mask:0xf bank_mask:0xf
v_add_f32_dpp v135, v135, v135 row_ror:8 row_mask:0xf bank_mask:0xf
v_mov_b32 v136, v134
v_mov_b32 v137, v135
s_nop 1
v_permlane16_swap_b32 v134, v136
v_permlane16_swap_b32 v135, v137
v_add_f32 v134, v134, v136
v_add_f32 v135, v135, v137
v_mov_b32 v136, v134
v_mov_b32 v137, v135
s_nop 1
v_permlane32_swap_b32 v134, v136
v_permlane32_swap_b32 v135, v137
v_add_f32 v134, v134, v136
v_add_f32 v135, v135, v137
v_cvt_pk_bf16_f32 v4, v134, v135
s_mov_b32 exec_lo, 0xff
s_mov_b32 exec_hi, 0x0
buffer_store_dword v4, v32, s[32:35], s47 offen
s_mov_b64 exec, -1
L_done_st:
L_done:
s_endpgm
L_w0:
s_mov_b32 s53, s46
s_waitcnt vmcnt(2)
buffer_load_dwordx4 v[54:57], v1, s[20:23], s53 offen offset:0 nt
s_waitcnt vmcnt(2)
buffer_load_dwordx4 v[58:61], v1, s[20:23], s53 offen offset:128 nt
s_waitcnt vmcnt(2)
buffer_load_dwordx4 v[62:65], v1, s[20:23], s53 offen offset:256 nt
s_load_dword s56, s[18:19], 0
s_mov_b32 s24, s6
s_mov_b32 s25, s7
s_mov_b32 s26, 100663296
s_mov_b32 s27, 0x20000
s_mov_b32 s28, s18
s_mov_b32 s29, s19
s_mov_b32 s30, 1024000
s_mov_b32 s31, 0x20000
s_mov_b32 s52, 0x3dd53b95
s_mov_b32 s58, 0xff00ff00
s_mov_b32 s59, 0xff00ff00
s_add_u32 s53, s53, 196608
s_waitcnt vmcnt(2)
buffer_load_dwordx4 v[66:69], v1, s[20:23], s53 offen offset:0 nt
s_waitcnt vmcnt(2)
buffer_load_dwordx4 v[70:73], v1, s[20:23], s53 offen offset:128 nt
s_waitcnt vmcnt(2)
buffer_load_dwordx4 v[74:77], v1, s[20:23], s53 offen offset:256 nt
v_mov_b32 v4, 0
v_mov_b32 v5, 0
ds_write_b64 v4, v[4:5] offset:832
v_lshlrev_b32 v3, 4, v0
v_mov_b32 v15, v3
v_and_b32 v30, 7, v0
v_lshlrev_b32 v30, 4, v30
v_lshrrev_b32 v2, 5, v0
v_lshl_add_u32 v30, v2, 3, v30
v_bfe_u32 v2, v0, 4, 1
v_lshl_add_u32 v30, v2, 2, v30
v_bfe_u32 v2, v0, 3, 1
v_lshl_add_u32 v31, v2, 1, v30
v_lshl_add_u32 v30, v2, 8, v30
s_lshl_b32 s49, s55, 10
s_add_u32 s49, s49, 8192
s_lshl_b32 s36, s44, 13
s_add_u32 s36, s36, 8192
s_add_u32 s37, s36, 4096
s_waitcnt lgkmcnt(0)
s_add_u32 s56, s56, 0x9e3779b9
s_barrier
ds_read_b128 v[214:217], v3 offset:2048
ds_read_b128 v[218:221], v3 offset:3072
ds_read_b128 v[222:225], v3 offset:4096
ds_read_b128 v[226:229], v3 offset:5120
ds_read_b128 v[230:233], v3 offset:6144
ds_read_b128 v[234:237], v3 offset:7168
ds_read_b128 v[238:241], v3 offset:8192
v_mov_b32 v9, s56
s_waitcnt lgkmcnt(0)
v_add_f32 v214, v214, v230
v_add_f32 v218, v218, v234
v_add_f32 v222, v222, v238
v_add_f32 v215, v215, v231
v_add_f32 v219, v219, v235
v_add_f32 v223, v223, v239
v_add_f32 v216, v216, v232
v_add_f32 v220, v220, v236
v_add_f32 v224, v224, v240
v_add_f32 v214, v214, v226
v_add_f32 v218, v218, v222
v_add_f32 v215, v215, v227
v_add_f32 v219, v219, v223
v_add_f32 v216, v216, v228
v_add_f32 v220, v220, v224
v_add_f32 v6, v214, v218
v_add_f32 v7, v215, v219
v_add_f32 v8, v216, v220
buffer_store_dwordx4 v[6:9], v3, s[28:31], s49 offen sc1
s_mov_b32 s38, 0
s_add_u32 s53, s53, 196608
s_waitcnt vmcnt(2)
buffer_load_dwordx4 v[78:81], v1, s[20:23], s53 offen offset:0 nt
s_waitcnt vmcnt(2)
buffer_load_dwordx4 v[82:85], v1, s[20:23], s53 offen offset:128 nt
s_waitcnt vmcnt(2)
buffer_load_dwordx4 v[86:89], v1, s[20:23], s53 offen offset:256 nt
s_add_u32 s53, s53, 196608
s_waitcnt vmcnt(2)
buffer_load_dwordx4 v[90:93], v1, s[20:23], s53 offen offset:0 nt
s_waitcnt vmcnt(2)
buffer_load_dwordx4 v[94:97], v1, s[20:23], s53 offen offset:128 nt
s_waitcnt vmcnt(2)
buffer_load_dwordx4 v[98:101], v1, s[20:23], s53 offen offset:256 nt
buffer_load_dwordx4 v[210:213], v15, s[28:31], s36 offen offset:0 sc1
buffer_load_dwordx4 v[214:217], v15, s[28:31], s36 offen offset:1024 sc1
buffer_load_dwordx4 v[218:221], v15, s[28:31], s36 offen offset:2048 sc1
buffer_load_dwordx4 v[222:225], v15, s[28:31], s36 offen offset:3072 sc1
buffer_load_dwordx4 v[226:229], v15, s[28:31], s37 offen offset:0 sc1
buffer_load_dwordx4 v[230:233], v15, s[28:31], s37 offen offset:1024 sc1
buffer_load_dwordx4 v[234:237], v15, s[28:31], s37 offen offset:2048 sc1
buffer_load_dwordx4 v[238:241], v15, s[28:31], s37 offen offset:3072 sc1
s_mov_b32 s38, 1
s_add_u32 s53, s53, 196608
s_waitcnt vmcnt(10)
buffer_load_dwordx4 v[102:105], v1, s[20:23], s53 offen offset:0 nt
s_waitcnt vmcnt(10)
buffer_load_dwordx4 v[106:109], v1, s[20:23], s53 offen offset:128 nt
s_waitcnt vmcnt(10)
buffer_load_dwordx4 v[110:113], v1, s[20:23], s53 offen offset:256 nt
s_cmp_eq_u32 s38, 2
s_cbranch_scc1 L_qs4
s_getpc_b64 s[98:99]
s_branch L_qstep
L_qs4:
s_add_u32 s53, s53, 196608
s_waitcnt vmcnt(2)
buffer_load_dwordx4 v[114:117], v1, s[20:23], s53 offen offset:0 nt
s_waitcnt vmcnt(2)
buffer_load_dwordx4 v[118:121], v1, s[20:23], s53 offen offset:128 nt
s_waitcnt vmcnt(2)
buffer_load_dwordx4 v[122:125], v1, s[20:23], s53 offen offset:256 nt
s_cmp_eq_u32 s38, 2
s_cbranch_scc1 L_qs5
s_getpc_b64 s[98:99]
s_branch L_qstep
L_qs5:
s_add_u32 s53, s53, 196608
s_waitcnt vmcnt(2)
buffer_load_dwordx4 v[126:129], v1, s[20:23], s53 offen offset:0 nt
s_waitcnt vmcnt(2)
buffer_load_dwordx4 v[130:133], v1, s[20:23], s53 offen offset:128 nt
s_waitcnt vmcnt(2)
buffer_load_dwordx4 v[134:137], v1, s[20:23], s53 offen offset:256 nt
s_cmp_eq_u32 s38, 2
s_cbranch_scc1 L_qs6
s_getpc_b64 s[98:99]
s_branch L_qstep
L_qs6:
s_add_u32 s53, s53, 196608
s_waitcnt vmcnt(2)
buffer_load_dwordx4 v[138:141], v1, s[20:23], s53 offen offset:0 nt
s_waitcnt vmcnt(2)
buffer_load_dwordx4 v[142:145], v1, s[20:23], s53 offen offset:128 nt
s_waitcnt vmcnt(2)
buffer_load_dwordx4 v[146:149], v1, s[20:23], s53 offen offset:256 nt
s_cmp_eq_u32 s38, 2
s_cbranch_scc1 L_qs7
s_getpc_b64 s[98:99]
s_branch L_qstep
L_qs7:
s_add_u32 s53, s53, 196608
s_waitcnt vmcnt(2)
buffer_load_dwordx4 v[150:153], v1, s[20:23], s53 offen offset:0 nt
s_waitcnt vmcnt(2)
buffer_load_dwordx4 v[154:157], v1, s[20:23], s53 offen offset:128 nt
s_waitcnt vmcnt(2)
buffer_load_dwordx4 v[158:161], v1, s[20:23], s53 offen offset:256 nt
s_cmp_eq_u32 s38, 2
s_cbranch_scc1 L_qs8
s_getpc_b64 s[98:99]
s_branch L_qstep
L_qs8:
s_add_u32 s53, s53, 196608
s_waitcnt vmcnt(2)
buffer_load_dwordx4 v[162:165], v1, s[20:23], s53 offen offset:0 nt
s_waitcnt vmcnt(2)
buffer_load_dwordx4 v[166:169], v1, s[20:23], s53 offen offset:128 nt
s_waitcnt vmcnt(2)
buffer_load_dwordx4 v[170:173], v1, s[20:23], s53 offen offset:256 nt
s_cmp_eq_u32 s38, 2
s_cbranch_scc1 L_qs9
s_getpc_b64 s[98:99]
s_branch L_qstep
L_qs9:
s_add_u32 s53, s53, 196608
s_waitcnt vmcnt(2)
buffer_load_dwordx4 v[174:177], v1, s[20:23], s53 offen offset:0 nt
s_waitcnt vmcnt(2)
buffer_load_dwordx4 v[178:181], v1, s[20:23], s53 offen offset:128 nt
s_waitcnt vmcnt(2)
buffer_load_dwordx4 v[182:185], v1, s[20:23], s53 offen offset:256 nt
s_cmp_eq_u32 s38, 2
s_cbranch_scc1 L_qfin
s_mov_b32 s51, 200000
L_qblock:
buffer_load_dwordx4 v[210:213], v15, s[28:31], s36 offen offset:0 sc1
buffer_load_dwordx4 v[214:217], v15, s[28:31], s36 offen offset:1024 sc1
buffer_load_dwordx4 v[218:221], v15, s[28:31], s36 offen offset:2048 sc1
buffer_load_dwordx4 v[222:225], v15, s[28:31], s36 offen offset:3072 sc1
buffer_load_dwordx4 v[226:229], v15, s[28:31], s37 offen offset:0 sc1
buffer_load_dwordx4 v[230:233], v15, s[28:31], s37 offen offset:1024 sc1
buffer_load_dwordx4 v[234:237], v15, s[28:31], s37 offen offset:2048 sc1
buffer_load_dwordx4 v[238:241], v15, s[28:31], s37 offen offset:3072 sc1
s_waitcnt vmcnt(0)
v_xor_b32 v2, s56, v213
v_xor_b32 v4, s56, v217
v_xor_b32 v5, s56, v221
v_or3_b32 v2, v2, v4, v5
v_xor_b32 v4, s56, v225
v_xor_b32 v5, s56, v229
v_or3_b32 v2, v2, v4, v5
v_xor_b32 v4, s56, v233
v_xor_b32 v5, s56, v237
v_or3_b32 v2, v2, v4, v5
v_xor_b32 v4, s56, v241
v_or_b32 v2, v2, v4
v_cmp_ne_u32 vcc, 0, v2
s_cbranch_vccz L_qblock_ok
s_sub_u32 s51, s51, 1
s_cmp_lg_u32 s51, 0
s_cbranch_scc1 L_qblock
L_qblock_ok:
v_add_f32 v210, v210, v226
v_add_f32 v211, v211, v227
v_add_f32 v212, v212, v228
v_add_f32 v214, v214, v230
v_add_f32 v215, v215, v231
v_add_f32 v216, v216, v232
v_add_f32 v218, v218, v234
v_add_f32 v219, v219, v235
v_add_f32 v220, v220, v236
v_add_f32 v222, v222, v238
v_add_f32 v223, v223, v239
v_add_f32 v224, v224, v240
v_add_f32 v210, v210, v218
v_add_f32 v211, v211, v219
v_add_f32 v212, v212, v220
v_add_f32 v214, v214, v222
v_add_f32 v215, v215, v223
v_add_f32 v216, v216, v224
v_add_f32 v210, v210, v214
v_add_f32 v211, v211, v215
v_add_f32 v212, v212, v216
v_cndmask_b32 v2, v210, v211, s[58:59]
v_cndmask_b32 v4, v211, v212, s[58:59]
v_cndmask_b32 v5, v212, v210, s[58:59]
v_cvt_pk_bf16_f32 v2, v2, v4
v_cvt_pk_bf16_f32 v5, v5, v5
ds_write_b32 v30, v2 offset:0
ds_write_b16 v31, v5 offset:128
v_mov_b32 v4, 0
v_mov_b32 v5, 1
s_waitcnt lgkmcnt(0)
ds_write_b32 v4, v5 offset:832
L_qfin:
s_waitcnt lgkmcnt(0)
v_and_b32 v2, 7, v0
v_lshlrev_b32 v2, 4, v2
ds_read_b128 v[30:33], v2 offset:0
ds_read_b128 v[34:37], v2 offset:128
ds_read_b128 v[38:41], v2 offset:256
s_waitcnt lgkmcnt(0)
s_add_u32 s53, s53, 196608
s_waitcnt vmcnt(2)
buffer_load_dwordx4 v[186:189], v1, s[20:23], s53 offen offset:0 nt
s_waitcnt vmcnt(31)
v_dot2_f32_bf16 v6, v54, v30, 0
v_dot2_f32_bf16 v7, v55, v31, 0
v_dot2_f32_bf16 v6, v56, v32, v6
v_dot2_f32_bf16 v7, v57, v33, v7
v_dot2_f32_bf16 v6, v58, v34, v6
v_dot2_f32_bf16 v7, v59, v35, v7
v_dot2_f32_bf16 v6, v60, v36, v6
v_dot2_f32_bf16 v7, v61, v37, v7
v_dot2_f32_bf16 v6, v62, v38, v6
v_dot2_f32_bf16 v7, v63, v39, v7
v_dot2_f32_bf16 v6, v64, v40, v6
v_dot2_f32_bf16 v7, v65, v41, v7
s_waitcnt vmcnt(2)
buffer_load_dwordx4 v[190:193], v1, s[20:23], s53 offen offset:128 nt
s_waitcnt vmcnt(29)
v_dot2_f32_bf16 v8, v66, v30, 0
v_dot2_f32_bf16 v9, v67, v31, 0
v_dot2_f32_bf16 v8, v68, v32, v8
v_add_f32 v6, v6, v7
v_dot2_f32_bf16 v9, v69, v33, v9
v_dot2_f32_bf16 v8, v70, v34, v8
v_dot2_f32_bf16 v9, v71, v35, v9
v_add_f32_dpp v6, v6, v6 quad_perm:[1,0,3,2] row_mask:0xf bank_mask:0xf
v_dot2_f32_bf16 v8, v72, v36, v8
v_dot2_f32_bf16 v9, v73, v37, v9
v_dot2_f32_bf16 v8, v74, v38, v8
v_add_f32_dpp v6, v6, v6 quad_perm:[2,3,0,1] row_mask:0xf bank_mask:0xf
v_dot2_f32_bf16 v9, v75, v39, v9
v_dot2_f32_bf16 v8, v76, v40, v8
v_dot2_f32_bf16 v9, v77, v41, v9
v_add_f32_dpp v13, v6, v6 row_half_mirror row_mask:0xf bank_mask:0xf
s_waitcnt vmcnt(2)
buffer_load_dwordx4 v[194:197], v1, s[20:23], s53 offen offset:256 nt
s_waitcnt vmcnt(27)
v_dot2_f32_bf16 v6, v78, v30, 0
v_dot2_f32_bf16 v7, v79, v31, 0
v_dot2_f32_bf16 v6, v80, v32, v6
v_add_f32 v8, v8, v9
v_dot2_f32_bf16 v7, v81, v33, v7
v_dot2_f32_bf16 v6, v82, v34, v6
v_dot2_f32_bf16 v7, v83, v35, v7
v_add_f32_dpp v8, v8, v8 quad_perm:[1,0,3,2] row_mask:0xf bank_mask:0xf
v_dot2_f32_bf16 v6, v84, v36, v6
v_dot2_f32_bf16 v7, v85, v37, v7
v_dot2_f32_bf16 v6, v86, v38, v6
v_add_f32_dpp v8, v8, v8 quad_perm:[2,3,0,1] row_mask:0xf bank_mask:0xf
v_dot2_f32_bf16 v7, v87, v39, v7
v_dot2_f32_bf16 v6, v88, v40, v6
v_dot2_f32_bf16 v7, v89, v41, v7
v_add_f32_dpp v14, v8, v8 row_half_mirror row_mask:0xf bank_mask:0xf
s_mov_b32 s32, s12
s_mov_b32 s33, s13
s_mov_b32 s34, 7864320
s_mov_b32 s35, 0x20000
s_mul_i32 s100, s44, 245760
s_mul_i32 s101, s45, 30720
s_add_u32 s100, s100, s101
s_lshl_b32 s101, s3, 10
s_add_u32 s101, s101, 0
v_lshlrev_b32 v3, 4, v0
v_add_u32 v3, s101, v3
s_waitcnt vmcnt(2)
buffer_load_dwordx4 v[42:45], v3, s[32:35], s100 offen
s_waitcnt vmcnt(25)
v_dot2_f32_bf16 v8, v90, v30, 0
v_dot2_f32_bf16 v9, v91, v31, 0
v_dot2_f32_bf16 v8, v92, v32, v8
v_add_f32 v6, v6, v7
v_dot2_f32_bf16 v9, v93, v33, v9
v_dot2_f32_bf16 v8, v94, v34, v8
v_dot2_f32_bf16 v9, v95, v35, v9
v_add_f32_dpp v6, v6, v6 quad_perm:[1,0,3,2] row_mask:0xf bank_mask:0xf
v_dot2_f32_bf16 v8, v96, v36, v8
v_dot2_f32_bf16 v9, v97, v37, v9
v_dot2_f32_bf16 v8, v98, v38, v8
v_add_f32_dpp v6, v6, v6 quad_perm:[2,3,0,1] row_mask:0xf bank_mask:0xf
v_dot2_f32_bf16 v9, v99, v39, v9
v_dot2_f32_bf16 v8, v100, v40, v8
v_dot2_f32_bf16 v9, v101, v41, v9
v_add_f32_dpp v15, v6, v6 row_half_mirror row_mask:0xf bank_mask:0xf
s_add_u32 s53, s53, 196608
s_waitcnt vmcnt(2)
buffer_load_dwordx4 v[198:201], v1, s[20:23], s53 offen offset:0 nt
s_waitcnt vmcnt(23)
v_dot2_f32_bf16 v6, v102, v30, 0
v_dot2_f32_bf16 v7, v103, v31, 0
v_dot2_f32_bf16 v6, v104, v32, v6
v_add_f32 v8, v8, v9
v_dot2_f32_bf16 v7, v105, v33, v7
v_dot2_f32_bf16 v6, v106, v34, v6
v_dot2_f32_bf16 v7, v107, v35, v7
v_add_f32_dpp v8, v8, v8 quad_perm:[1,0,3,2] row_mask:0xf bank_mask:0xf
v_dot2_f32_bf16 v6, v108, v36, v6
v_dot2_f32_bf16 v7, v109, v37, v7
v_dot2_f32_bf16 v6, v110, v38, v6
v_add_f32_dpp v8, v8, v8 quad_perm:[2,3,0,1] row_mask:0xf bank_mask:0xf
v_dot2_f32_bf16 v7, v111, v39, v7
v_dot2_f32_bf16 v6, v112, v40, v6
v_dot2_f32_bf16 v7, v113, v41, v7
v_add_f32_dpp v16, v8, v8 row_half_mirror row_mask:0xf bank_mask:0xf
s_waitcnt vmcnt(2)
buffer_load_dwordx4 v[202:205], v1, s[20:23], s53 offen offset:128 nt
s_waitcnt vmcnt(21)
v_dot2_f32_bf16 v8, v114, v30, 0
v_dot2_f32_bf16 v9, v115, v31, 0
v_dot2_f32_bf16 v8, v116, v32, v8
v_add_f32 v6, v6, v7
v_dot2_f32_bf16 v9, v117, v33, v9
v_dot2_f32_bf16 v8, v118, v34, v8
v_dot2_f32_bf16 v9, v119, v35, v9
v_add_f32_dpp v6, v6, v6 quad_perm:[1,0,3,2] row_mask:0xf bank_mask:0xf
v_dot2_f32_bf16 v8, v120, v36, v8
v_dot2_f32_bf16 v9, v121, v37, v9
v_dot2_f32_bf16 v8, v122, v38, v8
v_add_f32_dpp v6, v6, v6 quad_perm:[2,3,0,1] row_mask:0xf bank_mask:0xf
v_dot2_f32_bf16 v9, v123, v39, v9
v_dot2_f32_bf16 v8, v124, v40, v8
v_dot2_f32_bf16 v9, v125, v41, v9
v_add_f32_dpp v17, v6, v6 row_half_mirror row_mask:0xf bank_mask:0xf
s_waitcnt vmcnt(2)
buffer_load_dwordx4 v[206:209], v1, s[20:23], s53 offen offset:256 nt
s_waitcnt vmcnt(19)
v_dot2_f32_bf16 v6, v126, v30, 0
v_dot2_f32_bf16 v7, v127, v31, 0
v_dot2_f32_bf16 v6, v128, v32, v6
v_add_f32 v8, v8, v9
v_dot2_f32_bf16 v7, v129, v33, v7
v_dot2_f32_bf16 v6, v130, v34, v6
v_dot2_f32_bf16 v7, v131, v35, v7
v_add_f32_dpp v8, v8, v8 quad_perm:[1,0,3,2] row_mask:0xf bank_mask:0xf
v_dot2_f32_bf16 v6, v132, v36, v6
v_dot2_f32_bf16 v7, v133, v37, v7
v_dot2_f32_bf16 v6, v134, v38, v6
v_add_f32_dpp v8, v8, v8 quad_perm:[2,3,0,1] row_mask:0xf bank_mask:0xf
v_dot2_f32_bf16 v7, v135, v39, v7
v_dot2_f32_bf16 v6, v136, v40, v6
v_dot2_f32_bf16 v7, v137, v41, v7
v_add_f32_dpp v18, v8, v8 row_half_mirror row_mask:0xf bank_mask:0xf
s_lshl_b32 s101, s3, 10
s_add_u32 s101, s101, 8192
v_lshlrev_b32 v3, 4, v0
v_add_u32 v3, s101, v3
s_waitcnt vmcnt(2)
buffer_load_dwordx4 v[42:45], v3, s[32:35], s100 offen
s_waitcnt vmcnt(17)
v_dot2_f32_bf16 v8, v138, v30, 0
v_dot2_f32_bf16 v9, v139, v31, 0
v_dot2_f32_bf16 v8, v140, v32, v8
v_add_f32 v6, v6, v7
v_dot2_f32_bf16 v9, v141, v33, v9
v_dot2_f32_bf16 v8, v142, v34, v8
v_dot2_f32_bf16 v9, v143, v35, v9
v_add_f32_dpp v6, v6, v6 quad_perm:[1,0,3,2] row_mask:0xf bank_mask:0xf
v_dot2_f32_bf16 v8, v144, v36, v8
v_dot2_f32_bf16 v9, v145, v37, v9
v_dot2_f32_bf16 v8, v146, v38, v8
v_add_f32_dpp v6, v6, v6 quad_perm:[2,3,0,1] row_mask:0xf bank_mask:0xf
v_dot2_f32_bf16 v9, v147, v39, v9
v_dot2_f32_bf16 v8, v148, v40, v8
v_dot2_f32_bf16 v9, v149, v41, v9
v_add_f32_dpp v19, v6, v6 row_half_mirror row_mask:0xf bank_mask:0xf
s_add_u32 s53, s53, 196608
s_waitcnt vmcnt(2)
buffer_load_dwordx4 v[210:213], v1, s[20:23], s53 offen offset:0 nt
s_waitcnt vmcnt(15)
v_dot2_f32_bf16 v6, v150, v30, 0
v_dot2_f32_bf16 v7, v151, v31, 0
v_dot2_f32_bf16 v6, v152, v32, v6
v_add_f32 v8, v8, v9
v_dot2_f32_bf16 v7, v153, v33, v7
v_dot2_f32_bf16 v6, v154, v34, v6
v_dot2_f32_bf16 v7, v155, v35, v7
v_add_f32_dpp v8, v8, v8 quad_perm:[1,0,3,2] row_mask:0xf bank_mask:0xf
v_dot2_f32_bf16 v6, v156, v36, v6
v_dot2_f32_bf16 v7, v157, v37, v7
v_dot2_f32_bf16 v6, v158, v38, v6
v_add_f32_dpp v8, v8, v8 quad_perm:[2,3,0,1] row_mask:0xf bank_mask:0xf
v_dot2_f32_bf16 v7, v159, v39, v7
v_dot2_f32_bf16 v6, v160, v40, v6
v_dot2_f32_bf16 v7, v161, v41, v7
v_add_f32_dpp v20, v8, v8 row_half_mirror row_mask:0xf bank_mask:0xf
s_waitcnt vmcnt(2)
buffer_load_dwordx4 v[214:217], v1, s[20:23], s53 offen offset:128 nt
s_waitcnt vmcnt(13)
v_dot2_f32_bf16 v8, v162, v30, 0
v_dot2_f32_bf16 v9, v163, v31, 0
v_dot2_f32_bf16 v8, v164, v32, v8
v_add_f32 v6, v6, v7
v_dot2_f32_bf16 v9, v165, v33, v9
v_dot2_f32_bf16 v8, v166, v34, v8
v_dot2_f32_bf16 v9, v167, v35, v9
v_add_f32_dpp v6, v6, v6 quad_perm:[1,0,3,2] row_mask:0xf bank_mask:0xf
v_dot2_f32_bf16 v8, v168, v36, v8
v_dot2_f32_bf16 v9, v169, v37, v9
v_dot2_f32_bf16 v8, v170, v38, v8
v_add_f32_dpp v6, v6, v6 quad_perm:[2,3,0,1] row_mask:0xf bank_mask:0xf
v_dot2_f32_bf16 v9, v171, v39, v9
v_dot2_f32_bf16 v8, v172, v40, v8
v_dot2_f32_bf16 v9, v173, v41, v9
v_add_f32_dpp v21, v6, v6 row_half_mirror row_mask:0xf bank_mask:0xf
s_waitcnt vmcnt(2)
buffer_load_dwordx4 v[218:221], v1, s[20:23], s53 offen offset:256 nt
s_waitcnt vmcnt(11)
v_dot2_f32_bf16 v6, v174, v30, 0
v_dot2_f32_bf16 v7, v175, v31, 0
v_dot2_f32_bf16 v6, v176, v32, v6
v_add_f32 v8, v8, v9
v_dot2_f32_bf16 v7, v177, v33, v7
v_dot2_f32_bf16 v6, v178, v34, v6
v_dot2_f32_bf16 v7, v179, v35, v7
v_add_f32_dpp v8, v8, v8 quad_perm:[1,0,3,2] row_mask:0xf bank_mask:0xf
v_dot2_f32_bf16 v6, v180, v36, v6
v_dot2_f32_bf16 v7, v181, v37, v7
v_dot2_f32_bf16 v6, v182, v38, v6
v_add_f32_dpp v8, v8, v8 quad_perm:[2,3,0,1] row_mask:0xf bank_mask:0xf
v_dot2_f32_bf16 v7, v183, v39, v7
v_dot2_f32_bf16 v6, v184, v40, v6
v_dot2_f32_bf16 v7, v185, v41, v7
v_add_f32_dpp v22, v8, v8 row_half_mirror row_mask:0xf bank_mask:0xf
s_lshl_b32 s101, s3, 10
s_add_u32 s101, s101, 16384
v_lshlrev_b32 v3, 4, v0
v_add_u32 v3, s101, v3
s_waitcnt vmcnt(2)
buffer_load_dwordx4 v[42:45], v3, s[32:35], s100 offen
s_waitcnt vmcnt(9)
v_dot2_f32_bf16 v8, v186, v30, 0
v_dot2_f32_bf16 v9, v187, v31, 0
v_dot2_f32_bf16 v8, v188, v32, v8
v_add_f32 v6, v6, v7
v_dot2_f32_bf16 v9, v189, v33, v9
v_dot2_f32_bf16 v8, v190, v34, v8
v_dot2_f32_bf16 v9, v191, v35, v9
v_add_f32_dpp v6, v6, v6 quad_perm:[1,0,3,2] row_mask:0xf bank_mask:0xf
v_dot2_f32_bf16 v8, v192, v36, v8
v_dot2_f32_bf16 v9, v193, v37, v9
v_dot2_f32_bf16 v8, v194, v38, v8
v_add_f32_dpp v6, v6, v6 quad_perm:[2,3,0,1] row_mask:0xf bank_mask:0xf
v_dot2_f32_bf16 v9, v195, v39, v9
v_dot2_f32_bf16 v8, v196, v40, v8
v_dot2_f32_bf16 v9, v197, v41, v9
v_add_f32_dpp v23, v6, v6 row_half_mirror row_mask:0xf bank_mask:0xf
s_add_u32 s53, s53, 196608
s_waitcnt vmcnt(2)
buffer_load_dwordx4 v[222:225], v1, s[20:23], s53 offen offset:0 nt
s_waitcnt vmcnt(6)
v_dot2_f32_bf16 v6, v198, v30, 0
v_dot2_f32_bf16 v7, v199, v31, 0
v_dot2_f32_bf16 v6, v200, v32, v6
v_add_f32 v8, v8, v9
v_dot2_f32_bf16 v7, v201, v33, v7
v_dot2_f32_bf16 v6, v202, v34, v6
v_dot2_f32_bf16 v7, v203, v35, v7
v_add_f32_dpp v8, v8, v8 quad_perm:[1,0,3,2] row_mask:0xf bank_mask:0xf
v_dot2_f32_bf16 v6, v204, v36, v6
v_dot2_f32_bf16 v7, v205, v37, v7
v_dot2_f32_bf16 v6, v206, v38, v6
v_add_f32_dpp v8, v8, v8 quad_perm:[2,3,0,1] row_mask:0xf bank_mask:0xf
v_dot2_f32_bf16 v7, v207, v39, v7
v_dot2_f32_bf16 v6, v208, v40, v6
v_dot2_f32_bf16 v7, v209, v41, v7
v_add_f32_dpp v24, v8, v8 row_half_mirror row_mask:0xf bank_mask:0xf
s_waitcnt vmcnt(2)
buffer_load_dwordx4 v[226:229], v1, s[20:23], s53 offen offset:128 nt
s_waitcnt vmcnt(3)
v_dot2_f32_bf16 v8, v210, v30, 0
v_dot2_f32_bf16 v9, v211, v31, 0
v_dot2_f32_bf16 v8, v212, v32, v8
v_add_f32 v6, v6, v7
v_dot2_f32_bf16 v9, v213, v33, v9
v_dot2_f32_bf16 v8, v214, v34, v8
v_dot2_f32_bf16 v9, v215, v35, v9
v_add_f32_dpp v6, v6, v6 quad_perm:[1,0,3,2] row_mask:0xf bank_mask:0xf
v_dot2_f32_bf16 v8, v216, v36, v8
v_dot2_f32_bf16 v9, v217, v37, v9
v_dot2_f32_bf16 v8, v218, v38, v8
v_add_f32_dpp v6, v6, v6 quad_perm:[2,3,0,1] row_mask:0xf bank_mask:0xf
v_dot2_f32_bf16 v9, v219, v39, v9
v_dot2_f32_bf16 v8, v220, v40, v8
v_dot2_f32_bf16 v9, v221, v41, v9
v_add_f32_dpp v25, v6, v6 row_half_mirror row_mask:0xf bank_mask:0xf
s_waitcnt vmcnt(2)
buffer_load_dwordx4 v[230:233], v1, s[20:23], s53 offen offset:256 nt
s_cmp_ge_u32 s3, 6
s_cbranch_scc1 L_pf1
s_lshl_b32 s101, s3, 10
s_add_u32 s101, s101, 24576
v_lshlrev_b32 v3, 4, v0
v_add_u32 v3, s101, v3
s_waitcnt vmcnt(2)
buffer_load_dwordx4 v[42:45], v3, s[32:35], s100 offen
L_pf1:
s_add_u32 s53, s53, 196608
s_waitcnt vmcnt(2)
buffer_load_dwordx4 v[234:237], v1, s[20:23], s53 offen offset:0 nt
s_waitcnt vmcnt(2)
buffer_load_dwordx4 v[238:241], v1, s[20:23], s53 offen offset:128 nt
s_waitcnt vmcnt(2)
buffer_load_dwordx4 v[242:245], v1, s[20:23], s53 offen offset:256 nt
s_waitcnt vmcnt(3)
v_dot2_f32_bf16 v6, v222, v30, 0
v_dot2_f32_bf16 v7, v223, v31, 0
v_dot2_f32_bf16 v6, v224, v32, v6
v_add_f32 v8, v8, v9
v_dot2_f32_bf16 v7, v225, v33, v7
v_dot2_f32_bf16 v6, v226, v34, v6
v_dot2_f32_bf16 v7, v227, v35, v7
v_add_f32_dpp v8, v8, v8 quad_perm:[1,0,3,2] row_mask:0xf bank_mask:0xf
v_dot2_f32_bf16 v6, v228, v36, v6
v_dot2_f32_bf16 v7, v229, v37, v7
v_dot2_f32_bf16 v6, v230, v38, v6
v_add_f32_dpp v8, v8, v8 quad_perm:[2,3,0,1] row_mask:0xf bank_mask:0xf
v_dot2_f32_bf16 v7, v231, v39, v7
v_dot2_f32_bf16 v6, v232, v40, v6
v_dot2_f32_bf16 v7, v233, v41, v7
v_add_f32_dpp v26, v8, v8 row_half_mirror row_mask:0xf bank_mask:0xf
s_mov_b32 s54, s46
s_waitcnt vmcnt(2)
buffer_load_dwordx4 v[54:57], v1, s[24:27], s54 offen offset:0 nt
s_waitcnt vmcnt(2)
buffer_load_dwordx4 v[58:61], v1, s[24:27], s54 offen offset:128 nt
s_waitcnt vmcnt(2)
buffer_load_dwordx4 v[62:65], v1, s[24:27], s54 offen offset:256 nt
s_waitcnt vmcnt(3)
v_dot2_f32_bf16 v8, v234, v30, 0
v_dot2_f32_bf16 v9, v235, v31, 0
v_dot2_f32_bf16 v8, v236, v32, v8
v_add_f32 v6, v6, v7
v_dot2_f32_bf16 v9, v237, v33, v9
v_dot2_f32_bf16 v8, v238, v34, v8
v_dot2_f32_bf16 v9, v239, v35, v9
v_add_f32_dpp v6, v6, v6 quad_perm:[1,0,3,2] row_mask:0xf bank_mask:0xf
v_dot2_f32_bf16 v8, v240, v36, v8
v_dot2_f32_bf16 v9, v241, v37, v9
v_dot2_f32_bf16 v8, v242, v38, v8
v_add_f32_dpp v6, v6, v6 quad_perm:[2,3,0,1] row_mask:0xf bank_mask:0xf
v_dot2_f32_bf16 v9, v243, v39, v9
v_dot2_f32_bf16 v8, v244, v40, v8
v_dot2_f32_bf16 v9, v245, v41, v9
v_add_f32_dpp v27, v6, v6 row_half_mirror row_mask:0xf bank_mask:0xf
s_add_u32 s54, s54, 196608
s_waitcnt vmcnt(2)
buffer_load_dwordx4 v[66:69], v1, s[24:27], s54 offen offset:0 nt
s_nop 2
v_add_f32 v8, v8, v9
s_nop 1
v_add_f32_dpp v8, v8, v8 quad_perm:[1,0,3,2] row_mask:0xf bank_mask:0xf
s_nop 1
v_add_f32_dpp v8, v8, v8 quad_perm:[2,3,0,1] row_mask:0xf bank_mask:0xf
s_nop 1
v_add_f32_dpp v28, v8, v8 row_half_mirror row_mask:0xf bank_mask:0xf
s_nop 1
v_max3_f32 v6, v13, v14, v15
v_max3_f32 v6, v6, v16, v17
v_max3_f32 v6, v6, v18, v19
v_max3_f32 v6, v6, v20, v21
v_max3_f32 v6, v6, v22, v23
v_max3_f32 v6, v6, v24, v25
v_max3_f32 v6, v6, v26, v27
v_max_f32 v6, v6, v28
s_nop 1
v_max_f32_dpp v6, v6, v6 row_ror:8 row_mask:0xf bank_mask:0xf
v_mov_b32 v3, v6
s_nop 1
v_permlane16_swap_b32 v6, v3
v_max_f32 v6, v6, v3
v_mov_b32 v3, v6
s_nop 1
v_permlane32_swap_b32 v6, v3
v_max_f32 v6, v6, v3
v_mul_f32 v8, s52, v6
s_waitcnt vmcnt(2)
buffer_load_dwordx4 v[70:73], v1, s[24:27], s54 offen offset:128 nt
v_fma_f32 v13, v13, s52, -v8
v_fma_f32 v14, v14, s52, -v8
v_fma_f32 v15, v15, s52, -v8
v_fma_f32 v16, v16, s52, -v8
v_fma_f32 v17, v17, s52, -v8
v_fma_f32 v18, v18, s52, -v8
v_fma_f32 v19, v19, s52, -v8
v_fma_f32 v20, v20, s52, -v8
v_fma_f32 v21, v21, s52, -v8
v_fma_f32 v22, v22, s52, -v8
v_fma_f32 v23, v23, s52, -v8
v_fma_f32 v24, v24, s52, -v8
v_fma_f32 v25, v25, s52, -v8
v_fma_f32 v26, v26, s52, -v8
v_fma_f32 v27, v27, s52, -v8
v_fma_f32 v28, v28, s52, -v8
v_exp_f32 v13, v13
v_exp_f32 v14, v14
v_exp_f32 v15, v15
v_exp_f32 v16, v16
v_exp_f32 v17, v17
v_exp_f32 v18, v18
v_exp_f32 v19, v19
v_exp_f32 v20, v20
v_exp_f32 v21, v21
v_exp_f32 v22, v22
v_exp_f32 v23, v23
v_exp_f32 v24, v24
v_exp_f32 v25, v25
v_exp_f32 v26, v26
v_exp_f32 v27, v27
v_exp_f32 v28, v28
s_waitcnt vmcnt(2)
buffer_load_dwordx4 v[74:77], v1, s[24:27], s54 offen offset:256 nt
v_add_f32 v7, v13, v14
v_add_f32 v7, v7, v15
v_add_f32 v7, v7, v16
v_add_f32 v7, v7, v17
v_add_f32 v7, v7, v18
v_add_f32 v7, v7, v19
v_add_f32 v7, v7, v20
v_add_f32 v7, v7, v21
v_add_f32 v7, v7, v22
v_add_f32 v7, v7, v23
v_add_f32 v7, v7, v24
v_add_f32 v7, v7, v25
v_add_f32 v7, v7, v26
v_add_f32 v7, v7, v27
v_add_f32 v7, v7, v28
v_cvt_pk_bf16_f32 v13, v13, 0
v_cvt_pk_bf16_f32 v14, v14, 0
v_cvt_pk_bf16_f32 v15, v15, 0
v_cvt_pk_bf16_f32 v16, v16, 0
v_cvt_pk_bf16_f32 v17, v17, 0
v_cvt_pk_bf16_f32 v18, v18, 0
v_cvt_pk_bf16_f32 v19, v19, 0
v_cvt_pk_bf16_f32 v20, v20, 0
v_cvt_pk_bf16_f32 v21, v21, 0
v_cvt_pk_bf16_f32 v22, v22, 0
v_cvt_pk_bf16_f32 v23, v23, 0
v_cvt_pk_bf16_f32 v24, v24, 0
v_cvt_pk_bf16_f32 v25, v25, 0
v_cvt_pk_bf16_f32 v26, v26, 0
v_cvt_pk_bf16_f32 v27, v27, 0
v_cvt_pk_bf16_f32 v28, v28, 0
s_nop 1
v_add_f32_dpp v7, v7, v7 row_ror:8 row_mask:0xf bank_mask:0xf
v_mov_b32 v3, v7
s_nop 1
v_permlane16_swap_b32 v7, v3
v_add_f32 v7, v7, v3
v_mov_b32 v3, v7
s_nop 1
v_permlane32_swap_b32 v7, v3
v_add_f32 v7, v7, v3
s_lshl_b32 s47, s3, 3
v_mov_b32 v5, s47
ds_write_b64 v5, v[6:7] offset:768
v_mov_b32 v4, 0
v_mov_b32 v3, 1
s_waitcnt lgkmcnt(0)
s_mov_b64 exec, 1
ds_add_u32 v4, v3 offset:836
s_mov_b64 exec, -1
s_add_u32 s54, s54, 196608
s_waitcnt vmcnt(2)
buffer_load_dwordx4 v[78:81], v1, s[24:27], s54 offen offset:0 nt
s_mov_b32 s32, s12
s_mov_b32 s33, s13
s_mov_b32 s34, 7864320
s_mov_b32 s35, 0x20000
s_mul_i32 s100, s44, 245760
s_mul_i32 s101, s45, 160
s_add_u32 s100, s100, s101
s_mov_b32 s57, 429496730
v_mov_b32 v30, 0
v_mov_b32 v31, 0
v_mov_b32 v32, 0
v_mov_b32 v33, 0
v_mov_b32 v34, 0
v_mov_b32 v35, 0
v_mov_b32 v36, 0
v_mov_b32 v37, 0
v_mov_b32 v38, 0
v_mov_b32 v39, 0
v_mov_b32 v40, 0
v_mov_b32 v41, 0
v_mov_b32 v42, 0
v_mov_b32 v43, 0
v_mov_b32 v44, 0
v_mov_b32 v45, 0
v_mov_b32 v46, 0
v_mov_b32 v47, 0
v_mov_b32 v48, 0
v_mov_b32 v49, 0
v_mov_b32 v50, 0
v_mov_b32 v51, 0
v_mov_b32 v52, 0
v_mov_b32 v53, 0
v_lshlrev_b32 v10, 4, v0
s_lshl_b32 s47, s3, 10
v_add_u32 v11, s47, v10
s_waitcnt vmcnt(2)
buffer_load_dwordx4 v[82:85], v1, s[24:27], s54 offen offset:128 nt
s_waitcnt vmcnt(7)
v_lshlrev_b32 v2, 16, v13
v_dot2c_f32_bf16 v30, v54, v13
v_dot2c_f32_bf16 v31, v54, v2
v_dot2c_f32_bf16 v32, v55, v13
v_dot2c_f32_bf16 v33, v55, v2
v_dot2c_f32_bf16 v34, v56, v13
v_dot2c_f32_bf16 v35, v56, v2
v_dot2c_f32_bf16 v36, v57, v13
v_dot2c_f32_bf16 v37, v57, v2
s_waitcnt vmcnt(6)
v_dot2c_f32_bf16 v38, v58, v13
v_dot2c_f32_bf16 v39, v58, v2
v_dot2c_f32_bf16 v40, v59, v13
v_dot2c_f32_bf16 v41, v59, v2
v_dot2c_f32_bf16 v42, v60, v13
v_dot2c_f32_bf16 v43, v60, v2
v_dot2c_f32_bf16 v44, v61, v13
v_dot2c_f32_bf16 v45, v61, v2
s_waitcnt vmcnt(2)
buffer_load_dwordx4 v[86:89], v1, s[24:27], s54 offen offset:256 nt
s_waitcnt vmcnt(6)
v_dot2c_f32_bf16 v46, v62, v13
v_dot2c_f32_bf16 v47, v62, v2
v_dot2c_f32_bf16 v48, v63, v13
v_dot2c_f32_bf16 v49, v63, v2
v_dot2c_f32_bf16 v50, v64, v13
v_dot2c_f32_bf16 v51, v64, v2
v_dot2c_f32_bf16 v52, v65, v13
v_dot2c_f32_bf16 v53, v65, v2
s_waitcnt vmcnt(5)
v_lshlrev_b32 v2, 16, v14
v_dot2c_f32_bf16 v30, v66, v14
v_dot2c_f32_bf16 v31, v66, v2
v_dot2c_f32_bf16 v32, v67, v14
v_dot2c_f32_bf16 v33, v67, v2
v_dot2c_f32_bf16 v34, v68, v14
v_dot2c_f32_bf16 v35, v68, v2
v_dot2c_f32_bf16 v36, v69, v14
v_dot2c_f32_bf16 v37, v69, v2
s_add_u32 s54, s54, 196608
s_waitcnt vmcnt(2)
buffer_load_dwordx4 v[90:93], v1, s[24:27], s54 offen offset:0 nt
s_waitcnt vmcnt(5)
v_dot2c_f32_bf16 v38, v70, v14
v_dot2c_f32_bf16 v39, v70, v2
v_dot2c_f32_bf16 v40, v71, v14
v_dot2c_f32_bf16 v41, v71, v2
v_dot2c_f32_bf16 v42, v72, v14
v_dot2c_f32_bf16 v43, v72, v2
v_dot2c_f32_bf16 v44, v73, v14
v_dot2c_f32_bf16 v45, v73, v2
s_waitcnt vmcnt(4)
v_dot2c_f32_bf16 v46, v74, v14
v_dot2c_f32_bf16 v47, v74, v2
v_dot2c_f32_bf16 v48, v75, v14
v_dot2c_f32_bf16 v49, v75, v2
v_dot2c_f32_bf16 v50, v76, v14
v_dot2c_f32_bf16 v51, v76, v2
v_dot2c_f32_bf16 v52, v77, v14
v_dot2c_f32_bf16 v53, v77, v2
s_waitcnt vmcnt(2)
buffer_load_dwordx4 v[94:97], v1, s[24:27], s54 offen offset:128 nt
s_waitcnt vmcnt(4)
v_lshlrev_b32 v2, 16, v15
v_dot2c_f32_bf16 v30, v78, v15
v_dot2c_f32_bf16 v31, v78, v2
v_dot2c_f32_bf16 v32, v79, v15
v_dot2c_f32_bf16 v33, v79, v2
v_dot2c_f32_bf16 v34, v80, v15
v_dot2c_f32_bf16 v35, v80, v2
v_dot2c_f32_bf16 v36, v81, v15
v_dot2c_f32_bf16 v37, v81, v2
s_waitcnt vmcnt(2)
buffer_load_dwordx4 v[98:101], v1, s[24:27], s54 offen offset:256 nt
v_mov_b32 v4, 0
s_mov_b32 s51, 200000
L_c8:
ds_read_b32 v3, v4 offset:836
s_waitcnt lgkmcnt(0)
v_cmp_gt_u32 vcc, 8, v3
s_cbranch_vccz L_c8ok
s_sub_u32 s51, s51, 1
s_cmp_lg_u32 s51, 0
s_cbranch_scc1 L_c8
L_c8ok:
v_and_b32 v3, 7, v0
v_lshlrev_b32 v3, 3, v3
ds_read_b64 v[8:9], v3 offset:768
s_lshl_b32 s49, s55, 4
s_add_u32 s49, s49, 589824
s_waitcnt lgkmcnt(0)
v_mov_b32 v6, v8
s_nop 1
v_max_f32_dpp v6, v6, v6 quad_perm:[1,0,3,2] row_mask:0xf bank_mask:0xf
s_nop 1
v_max_f32_dpp v6, v6, v6 quad_perm:[2,3,0,1] row_mask:0xf bank_mask:0xf
s_nop 1
v_max_f32_dpp v6, v6, v6 row_half_mirror row_mask:0xf bank_mask:0xf
v_mul_f32 v3, s52, v6
v_fma_f32 v12, v8, s52, -v3
v_exp_f32 v12, v12
s_nop 0
v_mul_f32 v7, v12, v9
s_nop 1
v_add_f32_dpp v7, v7, v7 quad_perm:[1,0,3,2] row_mask:0xf bank_mask:0xf
s_nop 1
v_add_f32_dpp v7, v7, v7 quad_perm:[2,3,0,1] row_mask:0xf bank_mask:0xf
s_nop 1
v_add_f32_dpp v7, v7, v7 row_half_mirror row_mask:0xf bank_mask:0xf
v_mov_b32 v8, 0
v_mov_b32 v9, s56
s_mov_b64 exec, 1
buffer_store_dwordx4 v[6:9], off, s[28:31], s49 sc1
s_mov_b64 exec, -1
s_nop 1
s_lshl_b32 s101, s3, 6
s_add_u32 s101, s101, 0
v_add_u32 v3, s101, v0
v_mul_hi_u32 v4, v3, s57
v_mul_u32_u24 v5, 10, v4
v_sub_u32 v5, v3, v5
v_mul_u32_u24 v4, 1280, v4
v_lshl_add_u32 v4, v5, 4, v4
s_lshl_b32 s101, s101, 4
s_add_u32 m0, s101, 9216
s_waitcnt vmcnt(2)
buffer_load_dwordx4 v4, s[32:35], s100 offen nt lds
s_waitcnt vmcnt(6)
v_dot2c_f32_bf16 v38, v82, v15
v_dot2c_f32_bf16 v39, v82, v2
v_dot2c_f32_bf16 v40, v83, v15
v_dot2c_f32_bf16 v41, v83, v2
v_dot2c_f32_bf16 v42, v84, v15
v_dot2c_f32_bf16 v43, v84, v2
v_dot2c_f32_bf16 v44, v85, v15
v_dot2c_f32_bf16 v45, v85, v2
s_waitcnt vmcnt(5)
v_dot2c_f32_bf16 v46, v86, v15
v_dot2c_f32_bf16 v47, v86, v2
v_dot2c_f32_bf16 v48, v87, v15
v_dot2c_f32_bf16 v49, v87, v2
v_dot2c_f32_bf16 v50, v88, v15
v_dot2c_f32_bf16 v51, v88, v2
v_dot2c_f32_bf16 v52, v89, v15
v_dot2c_f32_bf16 v53, v89, v2
s_add_u32 s54, s54, 196608
s_waitcnt vmcnt(2)
buffer_load_dwordx4 v[102:105], v1, s[24:27], s54 offen offset:0 nt
s_waitcnt vmcnt(5)
v_lshlrev_b32 v2, 16, v16
v_dot2c_f32_bf16 v30, v90, v16
v_dot2c_f32_bf16 v31, v90, v2
v_dot2c_f32_bf16 v32, v91, v16
v_dot2c_f32_bf16 v33, v91, v2
v_dot2c_f32_bf16 v34, v92, v16
v_dot2c_f32_bf16 v35, v92, v2
v_dot2c_f32_bf16 v36, v93, v16
v_dot2c_f32_bf16 v37, v93, v2
s_waitcnt vmcnt(4)
v_dot2c_f32_bf16 v38, v94, v16
v_dot2c_f32_bf16 v39, v94, v2
v_dot2c_f32_bf16 v40, v95, v16
v_dot2c_f32_bf16 v41, v95, v2
v_dot2c_f32_bf16 v42, v96, v16
v_dot2c_f32_bf16 v43, v96, v2
v_dot2c_f32_bf16 v44, v97, v16
v_dot2c_f32_bf16 v45, v97, v2
s_waitcnt vmcnt(2)
buffer_load_dwordx4 v[106:109], v1, s[24:27], s54 offen offset:128 nt
s_waitcnt vmcnt(4)
v_dot2c_f32_bf16 v46, v98, v16
v_dot2c_f32_bf16 v47, v98, v2
v_dot2c_f32_bf16 v48, v99, v16
v_dot2c_f32_bf16 v49, v99, v2
v_dot2c_f32_bf16 v50, v100, v16
v_dot2c_f32_bf16 v51, v100, v2
v_dot2c_f32_bf16 v52, v101, v16
v_dot2c_f32_bf16 v53, v101, v2
s_waitcnt vmcnt(2)
buffer_load_dwordx4 v[110:113], v1, s[24:27], s54 offen offset:256 nt
s_lshl_b32 s101, s3, 6
s_add_u32 s101, s101, 512
v_add_u32 v3, s101, v0
v_mul_hi_u32 v4, v3, s57
v_mul_u32_u24 v5, 10, v4
v_sub_u32 v5, v3, v5
v_mul_u32_u24 v4, 1280, v4
v_lshl_add_u32 v4, v5, 4, v4
s_lshl_b32 s101, s101, 4
s_add_u32 m0, s101, 9216
s_waitcnt vmcnt(2)
buffer_load_dwordx4 v4, s[32:35], s100 offen nt lds
s_waitcnt vmcnt(3)
v_lshlrev_b32 v2, 16, v17
v_dot2c_f32_bf16 v30, v102, v17
v_dot2c_f32_bf16 v31, v102, v2
v_dot2c_f32_bf16 v32, v103, v17
v_dot2c_f32_bf16 v33, v103, v2
v_dot2c_f32_bf16 v34, v104, v17
v_dot2c_f32_bf16 v35, v104, v2
v_dot2c_f32_bf16 v36, v105, v17
v_dot2c_f32_bf16 v37, v105, v2
s_add_u32 s54, s54, 196608
s_waitcnt vmcnt(2)
buffer_load_dwordx4 v[114:117], v1, s[24:27], s54 offen offset:0 nt
s_waitcnt vmcnt(3)
v_dot2c_f32_bf16 v38, v106, v17
v_dot2c_f32_bf16 v39, v106, v2
v_dot2c_f32_bf16 v40, v107, v17
v_dot2c_f32_bf16 v41, v107, v2
v_dot2c_f32_bf16 v42, v108, v17
v_dot2c_f32_bf16 v43, v108, v2
v_dot2c_f32_bf16 v44, v109, v17
v_dot2c_f32_bf16 v45, v109, v2
s_waitcnt vmcnt(2)
buffer_load_dwordx4 v[118:121], v1, s[24:27], s54 offen offset:128 nt
s_waitcnt vmcnt(3)
v_dot2c_f32_bf16 v46, v110, v17
v_dot2c_f32_bf16 v47, v110, v2
v_dot2c_f32_bf16 v48, v111, v17
v_dot2c_f32_bf16 v49, v111, v2
v_dot2c_f32_bf16 v50, v112, v17
v_dot2c_f32_bf16 v51, v112, v2
v_dot2c_f32_bf16 v52, v113, v17
v_dot2c_f32_bf16 v53, v113, v2
s_waitcnt vmcnt(2)
buffer_load_dwordx4 v[122:125], v1, s[24:27], s54 offen offset:256 nt
s_lshl_b32 s101, s3, 6
s_add_u32 s101, s101, 1024
v_add_u32 v3, s101, v0
v_mul_hi_u32 v4, v3, s57
v_mul_u32_u24 v5, 10, v4
v_sub_u32 v5, v3, v5
v_mul_u32_u24 v4, 1280, v4
v_lshl_add_u32 v4, v5, 4, v4
s_lshl_b32 s101, s101, 4
s_add_u32 m0, s101, 9216
s_waitcnt vmcnt(2)
buffer_load_dwordx4 v4, s[32:35], s100 offen nt lds
s_waitcnt vmcnt(3)
v_lshlrev_b32 v2, 16, v18
v_dot2c_f32_bf16 v30, v114, v18
v_dot2c_f32_bf16 v31, v114, v2
v_dot2c_f32_bf16 v32, v115, v18
v_dot2c_f32_bf16 v33, v115, v2
v_dot2c_f32_bf16 v34, v116, v18
v_dot2c_f32_bf16 v35, v116, v2
v_dot2c_f32_bf16 v36, v117, v18
v_dot2c_f32_bf16 v37, v117, v2
s_add_u32 s54, s54, 196608
s_waitcnt vmcnt(2)
buffer_load_dwordx4 v[126:129], v1, s[24:27], s54 offen offset:0 nt
s_waitcnt vmcnt(3)
v_dot2c_f32_bf16 v38, v118, v18
v_dot2c_f32_bf16 v39, v118, v2
v_dot2c_f32_bf16 v40, v119, v18
v_dot2c_f32_bf16 v41, v119, v2
v_dot2c_f32_bf16 v42, v120, v18
v_dot2c_f32_bf16 v43, v120, v2
v_dot2c_f32_bf16 v44, v121, v18
v_dot2c_f32_bf16 v45, v121, v2
s_waitcnt vmcnt(2)
buffer_load_dwordx4 v[130:133], v1, s[24:27], s54 offen offset:128 nt
s_waitcnt vmcnt(3)
v_dot2c_f32_bf16 v46, v122, v18
v_dot2c_f32_bf16 v47, v122, v2
v_dot2c_f32_bf16 v48, v123, v18
v_dot2c_f32_bf16 v49, v123, v2
v_dot2c_f32_bf16 v50, v124, v18
v_dot2c_f32_bf16 v51, v124, v2
v_dot2c_f32_bf16 v52, v125, v18
v_dot2c_f32_bf16 v53, v125, v2
s_waitcnt vmcnt(2)
buffer_load_dwordx4 v[134:137], v1, s[24:27], s54 offen offset:256 nt
s_and_b32 s101, s3, 3
s_cmp_eq_u32 s101, 0
s_cbranch_scc1 L_wo2
s_lshr_b32 s101, s3, 2
s_sub_u32 s101, s3, s101
s_add_u32 s101, s101, 23
s_lshl_b32 s101, s101, 6
v_add_u32 v3, s101, v0
v_mul_hi_u32 v4, v3, s57
v_mul_u32_u24 v5, 10, v4
v_sub_u32 v5, v3, v5
v_mul_u32_u24 v4, 1280, v4
v_lshl_add_u32 v4, v5, 4, v4
s_lshl_b32 s101, s101, 4
s_add_u32 m0, s101, 9216
s_waitcnt vmcnt(2)
buffer_load_dwordx4 v4, s[32:35], s100 offen nt lds
L_wo2:
s_add_u32 s54, s54, 196608
s_waitcnt vmcnt(2)
buffer_load_dwordx4 v[138:141], v1, s[24:27], s54 offen offset:0 nt
s_waitcnt vmcnt(3)
v_lshlrev_b32 v2, 16, v19
v_dot2c_f32_bf16 v30, v126, v19
v_dot2c_f32_bf16 v31, v126, v2
v_dot2c_f32_bf16 v32, v127, v19
v_dot2c_f32_bf16 v33, v127, v2
v_dot2c_f32_bf16 v34, v128, v19
v_dot2c_f32_bf16 v35, v128, v2
v_dot2c_f32_bf16 v36, v129, v19
v_dot2c_f32_bf16 v37, v129, v2
s_waitcnt vmcnt(2)
buffer_load_dwordx4 v[142:145], v1, s[24:27], s54 offen offset:128 nt
s_waitcnt vmcnt(3)
v_dot2c_f32_bf16 v38, v130, v19
v_dot2c_f32_bf16 v39, v130, v2
v_dot2c_f32_bf16 v40, v131, v19
v_dot2c_f32_bf16 v41, v131, v2
v_dot2c_f32_bf16 v42, v132, v19
v_dot2c_f32_bf16 v43, v132, v2
v_dot2c_f32_bf16 v44, v133, v19
v_dot2c_f32_bf16 v45, v133, v2
s_waitcnt vmcnt(2)
buffer_load_dwordx4 v[146:149], v1, s[24:27], s54 offen offset:256 nt
s_waitcnt vmcnt(3)
v_dot2c_f32_bf16 v46, v134, v19
v_dot2c_f32_bf16 v47, v134, v2
v_dot2c_f32_bf16 v48, v135, v19
v_dot2c_f32_bf16 v49, v135, v2
v_dot2c_f32_bf16 v50, v136, v19
v_dot2c_f32_bf16 v51, v136, v2
v_dot2c_f32_bf16 v52, v137, v19
v_dot2c_f32_bf16 v53, v137, v2
s_add_u32 s54, s54, 196608
s_waitcnt vmcnt(2)
buffer_load_dwordx4 v[150:153], v1, s[24:27], s54 offen offset:0 nt
s_waitcnt vmcnt(3)
v_lshlrev_b32 v2, 16, v20
v_dot2c_f32_bf16 v30, v138, v20
v_dot2c_f32_bf16 v31, v138, v2
v_dot2c_f32_bf16 v32, v139, v20
v_dot2c_f32_bf16 v33, v139, v2
v_dot2c_f32_bf16 v34, v140, v20
v_dot2c_f32_bf16 v35, v140, v2
v_dot2c_f32_bf16 v36, v141, v20
v_dot2c_f32_bf16 v37, v141, v2
s_waitcnt vmcnt(2)
buffer_load_dwordx4 v[154:157], v1, s[24:27], s54 offen offset:128 nt
s_waitcnt vmcnt(3)
v_dot2c_f32_bf16 v38, v142, v20
v_dot2c_f32_bf16 v39, v142, v2
v_dot2c_f32_bf16 v40, v143, v20
v_dot2c_f32_bf16 v41, v143, v2
v_dot2c_f32_bf16 v42, v144, v20
v_dot2c_f32_bf16 v43, v144, v2
v_dot2c_f32_bf16 v44, v145, v20
v_dot2c_f32_bf16 v45, v145, v2
s_waitcnt vmcnt(2)
buffer_load_dwordx4 v[158:161], v1, s[24:27], s54 offen offset:256 nt
s_waitcnt vmcnt(3)
v_dot2c_f32_bf16 v46, v146, v20
v_dot2c_f32_bf16 v47, v146, v2
v_dot2c_f32_bf16 v48, v147, v20
v_dot2c_f32_bf16 v49, v147, v2
v_dot2c_f32_bf16 v50, v148, v20
v_dot2c_f32_bf16 v51, v148, v2
v_dot2c_f32_bf16 v52, v149, v20
v_dot2c_f32_bf16 v53, v149, v2
v_and_b32 v3, 7, v0
v_lshlrev_b32 v3, 4, v3
s_lshl_b32 s49, s44, 7
s_add_u32 s49, s49, 589824
buffer_load_dwordx4 v[6:9], v3, s[28:31], s49 offen sc1
s_waitcnt vmcnt(3)
v_lshlrev_b32 v2, 16, v21
v_dot2c_f32_bf16 v30, v150, v21
v_dot2c_f32_bf16 v31, v150, v2
v_dot2c_f32_bf16 v32, v151, v21
v_dot2c_f32_bf16 v33, v151, v2
v_dot2c_f32_bf16 v34, v152, v21
v_dot2c_f32_bf16 v35, v152, v2
v_dot2c_f32_bf16 v36, v153, v21
v_dot2c_f32_bf16 v37, v153, v2
s_add_u32 s54, s54, 196608
s_waitcnt vmcnt(2)
buffer_load_dwordx4 v[162:165], v1, s[24:27], s54 offen offset:0 nt
s_waitcnt vmcnt(3)
v_dot2c_f32_bf16 v38, v154, v21
v_dot2c_f32_bf16 v39, v154, v2
v_dot2c_f32_bf16 v40, v155, v21
v_dot2c_f32_bf16 v41, v155, v2
v_dot2c_f32_bf16 v42, v156, v21
v_dot2c_f32_bf16 v43, v156, v2
v_dot2c_f32_bf16 v44, v157, v21
v_dot2c_f32_bf16 v45, v157, v2
s_waitcnt vmcnt(2)
buffer_load_dwordx4 v[166:169], v1, s[24:27], s54 offen offset:128 nt
s_waitcnt vmcnt(3)
v_dot2c_f32_bf16 v46, v158, v21
v_dot2c_f32_bf16 v47, v158, v2
v_dot2c_f32_bf16 v48, v159, v21
v_dot2c_f32_bf16 v49, v159, v2
v_dot2c_f32_bf16 v50, v160, v21
v_dot2c_f32_bf16 v51, v160, v2
v_dot2c_f32_bf16 v52, v161, v21
v_dot2c_f32_bf16 v53, v161, v2
s_waitcnt vmcnt(2)
buffer_load_dwordx4 v[170:173], v1, s[24:27], s54 offen offset:256 nt
s_add_u32 s54, s54, 196608
s_waitcnt vmcnt(2)
buffer_load_dwordx4 v[174:177], v1, s[24:27], s54 offen offset:0 nt
s_waitcnt vmcnt(3)
v_lshlrev_b32 v2, 16, v22
v_dot2c_f32_bf16 v30, v162, v22
v_dot2c_f32_bf16 v31, v162, v2
v_dot2c_f32_bf16 v32, v163, v22
v_dot2c_f32_bf16 v33, v163, v2
v_dot2c_f32_bf16 v34, v164, v22
v_dot2c_f32_bf16 v35, v164, v2
v_dot2c_f32_bf16 v36, v165, v22
v_dot2c_f32_bf16 v37, v165, v2
s_waitcnt vmcnt(2)
buffer_load_dwordx4 v[178:181], v1, s[24:27], s54 offen offset:128 nt
s_waitcnt vmcnt(3)
v_dot2c_f32_bf16 v38, v166, v22
v_dot2c_f32_bf16 v39, v166, v2
v_dot2c_f32_bf16 v40, v167, v22
v_dot2c_f32_bf16 v41, v167, v2
v_dot2c_f32_bf16 v42, v168, v22
v_dot2c_f32_bf16 v43, v168, v2
v_dot2c_f32_bf16 v44, v169, v22
v_dot2c_f32_bf16 v45, v169, v2
s_waitcnt vmcnt(2)
buffer_load_dwordx4 v[182:185], v1, s[24:27], s54 offen offset:256 nt
s_waitcnt vmcnt(6)
s_mov_b32 s51, 200000
L_stchk:
v_cmp_ne_u32 vcc, s56, v9
s_cbranch_vccz L_stok
v_and_b32 v3, 7, v0
v_lshlrev_b32 v3, 4, v3
s_lshl_b32 s49, s44, 7
s_add_u32 s49, s49, 589824
buffer_load_dwordx4 v[6:9], v3, s[28:31], s49 offen sc1
s_waitcnt vmcnt(0)
s_sub_u32 s51, s51, 1
s_cmp_lg_u32 s51, 0
s_cbranch_scc1 L_stchk
L_stok:
v_mov_b32 v3, v6
s_nop 1
v_max_f32_dpp v3, v3, v3 quad_perm:[1,0,3,2] row_mask:0xf bank_mask:0xf
s_nop 1
v_max_f32_dpp v3, v3, v3 quad_perm:[2,3,0,1] row_mask:0xf bank_mask:0xf
s_nop 1
v_max_f32_dpp v3, v3, v3 row_half_mirror row_mask:0xf bank_mask:0xf
v_mul_f32 v3, s52, v3
v_fma_f32 v3, v6, s52, -v3
v_exp_f32 v3, v3
s_nop 0
v_mul_f32 v4, v3, v7
s_nop 1
v_add_f32_dpp v4, v4, v4 quad_perm:[1,0,3,2] row_mask:0xf bank_mask:0xf
s_nop 1
v_add_f32_dpp v4, v4, v4 quad_perm:[2,3,0,1] row_mask:0xf bank_mask:0xf
s_nop 1
v_add_f32_dpp v4, v4, v4 row_half_mirror row_mask:0xf bank_mask:0xf
v_rcp_f32 v4, v4
s_nop 0
v_mul_f32 v3, v3, v4
s_nop 0
v_readlane_b32 s40, v3, s45
s_nop 1
v_mul_f32 v12, s40, v12
s_nop 0
v_readlane_b32 s4, v12, 0
v_readlane_b32 s5, v12, 1
v_readlane_b32 s6, v12, 2
v_readlane_b32 s7, v12, 3
v_readlane_b32 s8, v12, 4
v_readlane_b32 s9, v12, 5
v_readlane_b32 s10, v12, 6
v_readlane_b32 s11, v12, 7
s_add_u32 s54, s54, 196608
s_waitcnt vmcnt(2)
buffer_load_dwordx4 v[186:189], v1, s[24:27], s54 offen offset:0 nt
s_waitcnt vmcnt(4)
v_dot2c_f32_bf16 v46, v170, v22
v_dot2c_f32_bf16 v47, v170, v2
v_dot2c_f32_bf16 v48, v171, v22
v_dot2c_f32_bf16 v49, v171, v2
v_dot2c_f32_bf16 v50, v172, v22
v_dot2c_f32_bf16 v51, v172, v2
v_dot2c_f32_bf16 v52, v173, v22
v_dot2c_f32_bf16 v53, v173, v2
s_waitcnt vmcnt(2)
buffer_load_dwordx4 v[190:193], v1, s[24:27], s54 offen offset:128 nt
s_waitcnt vmcnt(4)
v_lshlrev_b32 v2, 16, v23
v_dot2c_f32_bf16 v30, v174, v23
v_dot2c_f32_bf16 v31, v174, v2
v_dot2c_f32_bf16 v32, v175, v23
v_dot2c_f32_bf16 v33, v175, v2
v_dot2c_f32_bf16 v34, v176, v23
v_dot2c_f32_bf16 v35, v176, v2
v_dot2c_f32_bf16 v36, v177, v23
v_dot2c_f32_bf16 v37, v177, v2
s_waitcnt vmcnt(2)
buffer_load_dwordx4 v[194:197], v1, s[24:27], s54 offen offset:256 nt
s_waitcnt vmcnt(4)
v_dot2c_f32_bf16 v38, v178, v23
v_dot2c_f32_bf16 v39, v178, v2
v_dot2c_f32_bf16 v40, v179, v23
v_dot2c_f32_bf16 v41, v179, v2
v_dot2c_f32_bf16 v42, v180, v23
v_dot2c_f32_bf16 v43, v180, v2
v_dot2c_f32_bf16 v44, v181, v23
v_dot2c_f32_bf16 v45, v181, v2
s_add_u32 s54, s54, 196608
s_waitcnt vmcnt(2)
buffer_load_dwordx4 v[198:201], v1, s[24:27], s54 offen offset:0 nt
s_waitcnt vmcnt(4)
v_dot2c_f32_bf16 v46, v182, v23
v_dot2c_f32_bf16 v47, v182, v2
v_dot2c_f32_bf16 v48, v183, v23
v_dot2c_f32_bf16 v49, v183, v2
v_dot2c_f32_bf16 v50, v184, v23
v_dot2c_f32_bf16 v51, v184, v2
v_dot2c_f32_bf16 v52, v185, v23
v_dot2c_f32_bf16 v53, v185, v2
s_waitcnt vmcnt(2)
buffer_load_dwordx4 v[202:205], v1, s[24:27], s54 offen offset:128 nt
s_waitcnt vmcnt(4)
v_lshlrev_b32 v2, 16, v24
v_dot2c_f32_bf16 v30, v186, v24
v_dot2c_f32_bf16 v31, v186, v2
v_dot2c_f32_bf16 v32, v187, v24
v_dot2c_f32_bf16 v33, v187, v2
v_dot2c_f32_bf16 v34, v188, v24
v_dot2c_f32_bf16 v35, v188, v2
v_dot2c_f32_bf16 v36, v189, v24
v_dot2c_f32_bf16 v37, v189, v2
s_waitcnt vmcnt(2)
buffer_load_dwordx4 v[206:209], v1, s[24:27], s54 offen offset:256 nt
s_waitcnt vmcnt(4)
v_dot2c_f32_bf16 v38, v190, v24
v_dot2c_f32_bf16 v39, v190, v2
v_dot2c_f32_bf16 v40, v191, v24
v_dot2c_f32_bf16 v41, v191, v2
v_dot2c_f32_bf16 v42, v192, v24
v_dot2c_f32_bf16 v43, v192, v2
v_dot2c_f32_bf16 v44, v193, v24
v_dot2c_f32_bf16 v45, v193, v2
s_add_u32 s54, s54, 196608
s_waitcnt vmcnt(5)
buffer_load_dwordx4 v[210:213], v1, s[24:27], s54 offen offset:0 nt
s_waitcnt vmcnt(5)
buffer_load_dwordx4 v[214:217], v1, s[24:27], s54 offen offset:128 nt
s_waitcnt vmcnt(5)
buffer_load_dwordx4 v[218:221], v1, s[24:27], s54 offen offset:256 nt
s_waitcnt vmcnt(6)
v_dot2c_f32_bf16 v46, v194, v24
v_dot2c_f32_bf16 v47, v194, v2
v_dot2c_f32_bf16 v48, v195, v24
v_dot2c_f32_bf16 v49, v195, v2
v_dot2c_f32_bf16 v50, v196, v24
v_dot2c_f32_bf16 v51, v196, v2
v_dot2c_f32_bf16 v52, v197, v24
v_dot2c_f32_bf16 v53, v197, v2
s_add_u32 s54, s54, 196608
s_waitcnt vmcnt(5)
buffer_load_dwordx4 v[222:225], v1, s[24:27], s54 offen offset:0 nt
s_waitcnt vmcnt(6)
v_lshlrev_b32 v2, 16, v25
v_dot2c_f32_bf16 v30, v198, v25
v_dot2c_f32_bf16 v31, v198, v2
v_dot2c_f32_bf16 v32, v199, v25
v_dot2c_f32_bf16 v33, v199, v2
v_dot2c_f32_bf16 v34, v200, v25
v_dot2c_f32_bf16 v35, v200, v2
v_dot2c_f32_bf16 v36, v201, v25
v_dot2c_f32_bf16 v37, v201, v2
s_waitcnt vmcnt(5)
buffer_load_dwordx4 v[226:229], v1, s[24:27], s54 offen offset:128 nt
s_waitcnt vmcnt(6)
v_dot2c_f32_bf16 v38, v202, v25
v_dot2c_f32_bf16 v39, v202, v2
v_dot2c_f32_bf16 v40, v203, v25
v_dot2c_f32_bf16 v41, v203, v2
v_dot2c_f32_bf16 v42, v204, v25
v_dot2c_f32_bf16 v43, v204, v2
v_dot2c_f32_bf16 v44, v205, v25
v_dot2c_f32_bf16 v45, v205, v2
s_waitcnt vmcnt(5)
buffer_load_dwordx4 v[230:233], v1, s[24:27], s54 offen offset:256 nt
s_waitcnt vmcnt(6)
v_dot2c_f32_bf16 v46, v206, v25
v_dot2c_f32_bf16 v47, v206, v2
v_dot2c_f32_bf16 v48, v207, v25
v_dot2c_f32_bf16 v49, v207, v2
v_dot2c_f32_bf16 v50, v208, v25
v_dot2c_f32_bf16 v51, v208, v2
v_dot2c_f32_bf16 v52, v209, v25
v_dot2c_f32_bf16 v53, v209, v2
s_add_u32 s54, s54, 196608
s_waitcnt vmcnt(5)
buffer_load_dwordx4 v[234:237], v1, s[24:27], s54 offen offset:0 nt
s_waitcnt vmcnt(6)
v_lshlrev_b32 v2, 16, v26
v_dot2c_f32_bf16 v30, v210, v26
v_dot2c_f32_bf16 v31, v210, v2
v_dot2c_f32_bf16 v32, v211, v26
v_dot2c_f32_bf16 v33, v211, v2
v_dot2c_f32_bf16 v34, v212, v26
v_dot2c_f32_bf16 v35, v212, v2
v_dot2c_f32_bf16 v36, v213, v26
v_dot2c_f32_bf16 v37, v213, v2
s_waitcnt vmcnt(5)
buffer_load_dwordx4 v[238:241], v1, s[24:27], s54 offen offset:128 nt
s_waitcnt vmcnt(6)
v_dot2c_f32_bf16 v38, v214, v26
v_dot2c_f32_bf16 v39, v214, v2
v_dot2c_f32_bf16 v40, v215, v26
v_dot2c_f32_bf16 v41, v215, v2
v_dot2c_f32_bf16 v42, v216, v26
v_dot2c_f32_bf16 v43, v216, v2
v_dot2c_f32_bf16 v44, v217, v26
v_dot2c_f32_bf16 v45, v217, v2
s_waitcnt vmcnt(5)
buffer_load_dwordx4 v[242:245], v1, s[24:27], s54 offen offset:256 nt
s_waitcnt vmcnt(6)
v_dot2c_f32_bf16 v46, v218, v26
v_dot2c_f32_bf16 v47, v218, v2
v_dot2c_f32_bf16 v48, v219, v26
v_dot2c_f32_bf16 v49, v219, v2
v_dot2c_f32_bf16 v50, v220, v26
v_dot2c_f32_bf16 v51, v220, v2
v_dot2c_f32_bf16 v52, v221, v26
v_dot2c_f32_bf16 v53, v221, v2
s_waitcnt vmcnt(5)
v_lshlrev_b32 v2, 16, v27
v_dot2c_f32_bf16 v30, v222, v27
v_dot2c_f32_bf16 v31, v222, v2
v_dot2c_f32_bf16 v32, v223, v27
v_dot2c_f32_bf16 v33, v223, v2
v_dot2c_f32_bf16 v34, v224, v27
v_dot2c_f32_bf16 v35, v224, v2
v_dot2c_f32_bf16 v36, v225, v27
v_dot2c_f32_bf16 v37, v225, v2
s_waitcnt vmcnt(4)
v_dot2c_f32_bf16 v38, v226, v27
v_dot2c_f32_bf16 v39, v226, v2
v_dot2c_f32_bf16 v40, v227, v27
v_dot2c_f32_bf16 v41, v227, v2
v_dot2c_f32_bf16 v42, v228, v27
v_dot2c_f32_bf16 v43, v228, v2
v_dot2c_f32_bf16 v44, v229, v27
v_dot2c_f32_bf16 v45, v229, v2
s_waitcnt vmcnt(3)
v_dot2c_f32_bf16 v46, v230, v27
v_dot2c_f32_bf16 v47, v230, v2
v_dot2c_f32_bf16 v48, v231, v27
v_dot2c_f32_bf16 v49, v231, v2
v_dot2c_f32_bf16 v50, v232, v27
v_dot2c_f32_bf16 v51, v232, v2
v_dot2c_f32_bf16 v52, v233, v27
v_dot2c_f32_bf16 v53, v233, v2
s_waitcnt vmcnt(2)
v_lshlrev_b32 v2, 16, v28
v_dot2c_f32_bf16 v30, v234, v28
v_dot2c_f32_bf16 v31, v234, v2
v_dot2c_f32_bf16 v32, v235, v28
v_dot2c_f32_bf16 v33, v235, v2
v_dot2c_f32_bf16 v34, v236, v28
v_dot2c_f32_bf16 v35, v236, v2
v_dot2c_f32_bf16 v36, v237, v28
v_dot2c_f32_bf16 v37, v237, v2
s_waitcnt vmcnt(1)
v_dot2c_f32_bf16 v38, v238, v28
v_dot2c_f32_bf16 v39, v238, v2
v_dot2c_f32_bf16 v40, v239, v28
v_dot2c_f32_bf16 v41, v239, v2
v_dot2c_f32_bf16 v42, v240, v28
v_dot2c_f32_bf16 v43, v240, v2
v_dot2c_f32_bf16 v44, v241, v28
v_dot2c_f32_bf16 v45, v241, v2
s_waitcnt vmcnt(0)
v_dot2c_f32_bf16 v46, v242, v28
v_dot2c_f32_bf16 v47, v242, v2
v_dot2c_f32_bf16 v48, v243, v28
v_dot2c_f32_bf16 v49, v243, v2
v_dot2c_f32_bf16 v50, v244, v28
v_dot2c_f32_bf16 v51, v244, v2
v_dot2c_f32_bf16 v52, v245, v28
v_dot2c_f32_bf16 v53, v245, v2
v_mov_b32 v9, s56
s_branch L_tail
L_qstep:
s_add_u32 s98, s98, 4
s_addc_u32 s99, s99, 0
s_waitcnt vmcnt(3)
v_xor_b32 v2, s56, v213
v_xor_b32 v4, s56, v217
v_xor_b32 v5, s56, v221
v_or3_b32 v2, v2, v4, v5
v_xor_b32 v4, s56, v225
v_xor_b32 v5, s56, v229
v_or3_b32 v2, v2, v4, v5
v_xor_b32 v4, s56, v233
v_xor_b32 v5, s56, v237
v_or3_b32 v2, v2, v4, v5
v_xor_b32 v4, s56, v241
v_or_b32 v2, v2, v4
v_cmp_ne_u32 vcc, 0, v2
s_cbranch_vccnz L_qissue
v_add_f32 v210, v210, v226
v_add_f32 v211, v211, v227
v_add_f32 v212, v212, v228
v_add_f32 v214, v214, v230
v_add_f32 v215, v215, v231
v_add_f32 v216, v216, v232
v_add_f32 v218, v218, v234
v_add_f32 v219, v219, v235
v_add_f32 v220, v220, v236
v_add_f32 v222, v222, v238
v_add_f32 v223, v223, v239
v_add_f32 v224, v224, v240
v_add_f32 v210, v210, v218
v_add_f32 v211, v211, v219
v_add_f32 v212, v212, v220
v_add_f32 v214, v214, v222
v_add_f32 v215, v215, v223
v_add_f32 v216, v216, v224
v_add_f32 v210, v210, v214
v_add_f32 v211, v211, v215
v_add_f32 v212, v212, v216
v_cndmask_b32 v2, v210, v211, s[58:59]
v_cndmask_b32 v4, v211, v212, s[58:59]
v_cndmask_b32 v5, v212, v210, s[58:59]
v_cvt_pk_bf16_f32 v2, v2, v4
v_cvt_pk_bf16_f32 v5, v5, v5
ds_write_b32 v30, v2 offset:0
ds_write_b16 v31, v5 offset:128
v_mov_b32 v4, 0
v_mov_b32 v5, 1
s_waitcnt lgkmcnt(0)
ds_write_b32 v4, v5 offset:832
s_mov_b32 s38, 2
s_setpc_b64 s[98:99]
L_qissue:
buffer_load_dwordx4 v[210:213], v15, s[28:31], s36 offen offset:0 sc1
buffer_load_dwordx4 v[214:217], v15, s[28:31], s36 offen offset:1024 sc1
buffer_load_dwordx4 v[218:221], v15, s[28:31], s36 offen offset:2048 sc1
buffer_load_dwordx4 v[222:225], v15, s[28:31], s36 offen offset:3072 sc1
buffer_load_dwordx4 v[226:229], v15, s[28:31], s37 offen offset:0 sc1
buffer_load_dwordx4 v[230:233], v15, s[28:31], s37 offen offset:1024 sc1
buffer_load_dwordx4 v[234:237], v15, s[28:31], s37 offen offset:2048 sc1
buffer_load_dwordx4 v[238:241], v15, s[28:31], s37 offen offset:3072 sc1
s_mov_b32 s38, 1
s_setpc_b64 s[98:99]
.section .rodata,"a"
.p2align 6
.amdhsa_kernel standalone__gqa_block_cached__decode_kernel
  .amdhsa_next_free_vgpr 246
  .amdhsa_next_free_sgpr 102
  .amdhsa_accum_offset 248
  .amdhsa_group_segment_fixed_size 0
  .amdhsa_kernarg_size 64
  .amdhsa_user_sgpr_count 2
  .amdhsa_user_sgpr_kernarg_segment_ptr 1
  .amdhsa_system_sgpr_workgroup_id_x 1
.end_amdhsa_kernel
```
